```python
import torch

def _softmax(x, axis=-1):
    return torch.softmax(x, dim=axis)
def _gelu(x):
    return torch.nn.functional.gelu(x, approximate="tanh")
def _silu(x):
    return torch.nn.functional.silu(x)
def _sigmoid(x):
    return torch.sigmoid(x)
def _layernorm(x, axis=-1, eps=1e-5):
    m = x.mean(dim=axis, keepdim=True)
    v = x.var(dim=axis, keepdim=True, unbiased=False)
    return (x - m) / torch.sqrt(v + eps)
def _scatter_add(tgt, idx, src, axis=0):
    return tgt.clone().index_add_(axis, idx, src)
def _segment_sum(src, seg, n):
    out = torch.zeros((n,) + src.shape[1:], dtype=src.dtype)
    return out.index_add_(0, seg, src)
def _pad(x, pw):
    flat = tuple(v for pair in reversed(pw) for v in pair)
    return torch.nn.functional.pad(x, flat)

kernel_name = 'recurrent_scan__softmax_full_mha__geglu_ffn__prompt'

def setup_inputs():

    _w = (lambda a: (lambda t: t.to(torch.bfloat16) if t.is_floating_point() else t)(torch.as_tensor(a)))
    def _A_setup():
        B, S, D = 1, 2048, 1024
        return {
            "x": _w((lambda *s: torch.randn(*s, dtype=torch.bfloat16) * 0.05)(B, S, D)),
            "wqkv": _w((lambda *s: torch.randn(*s, dtype=torch.bfloat16) * 0.05)(D, 3 * D)),
            "wo": _w((lambda *s: torch.randn(*s, dtype=torch.bfloat16) * 0.05)(D, D)),
        }
    _A_in = _A_setup()

    def _B_setup():
        B, S, D, F = 1, 2048, 1024, 3584
        return {
            "x": _w((lambda *s: torch.randn(*s, dtype=torch.bfloat16) * 0.05)(B, S, D)),
            "w_gate": _w((lambda *s: torch.randn(*s, dtype=torch.bfloat16) * 0.05)(D, F)),
            "w_up": _w((lambda *s: torch.randn(*s, dtype=torch.bfloat16) * 0.05)(D, F)),
            "w_down": _w((lambda *s: torch.randn(*s, dtype=torch.bfloat16) * 0.05)(F, D)),
        }
    _B_in = _B_setup()

    return {
        "A_x": _A_in["x"],
        "A_wqkv": _A_in["wqkv"],
        "A_wo": _A_in["wo"],
        "B_x": _B_in["x"],
        "B_w_gate": _B_in["w_gate"],
        "B_w_up": _B_in["w_up"],
        "B_w_down": _B_in["w_down"],
    }

def reference(A_x, A_wqkv, A_wo, B_x, B_w_gate, B_w_up, B_w_down):
    def _A_ref(x, wqkv, wo):
        B, S, D = x.shape
        H = 32; Dh = D // H
        qkv = (lambda x, *d: x.permute(*d))((x @ wqkv).reshape(B, S, 3, H, Dh), 2, 0, 3, 1, 4)
        q, k, v = qkv[0], qkv[1], qkv[2]
        scale = Dh ** -0.5
        scores = torch.einsum("bhqd,bhkd->bhqk", q, k) * scale
        p = _softmax(scores, axis=-1)
        o = torch.einsum("bhqk,bhkd->bhqd", p, v)
        return (lambda x, *d: x.permute(*d))(o, 0, 2, 1, 3).reshape(B, S, D) @ wo

    def _B_ref(x, w_gate, w_up, w_down):
        return (_gelu(x @ w_gate) * (x @ w_up)) @ w_down

    x = A_x
    xn = _layernorm(x, axis=-1)
    s = _A_ref(xn, A_wqkv, A_wo)
    g = _silu(_B_ref(xn, B_w_gate, B_w_up, B_w_down))
    return x + s * g
```

```asm
; @launch kernel=mega_kernel grid=(256,1,1) block=(512,1,1) lds=163840
.amdgcn_target "amdgcn-amd-amdhsa--gfx950"
.text
.globl mega_kernel
.p2align 8
.type mega_kernel,@function
mega_kernel:
  s_cmp_ge_u32 s2, 256
  s_cbranch_scc1 mega_end
  s_load_dwordx2 s[40:41], s[0:1], 0
  s_load_dwordx2 s[12:13], s[0:1], 8
  s_load_dwordx4 s[32:35], s[0:1], 32
  s_load_dwordx2 s[36:37], s[0:1], 72
  s_load_dwordx2 s[52:53], s[0:1], 16
  s_load_dwordx2 s[56:57], s[0:1], 48
  s_bfe_u32 s26, s2, 0x30003
  s_lshr_b32 s27, s2, 6
  s_and_b32 s23, s2, 7
  s_lshl_b32 s61, s26, 5
  s_lshl_b32 s28, s23, 2
  s_add_u32 s61, s61, s28
  s_add_u32 s61, s61, s27
  v_and_b32 v26, 7, v0
  v_lshrrev_b32 v27, 3, v0
  v_lshlrev_b32 v25, 11, v26
  v_lshl_add_u32 v25, v27, 4, v25
  s_lshl_b32 s28, s61, 14
  s_waitcnt lgkmcnt(0)
  s_mov_b32 s42, 4194304
  s_mov_b32 s43, 0x20000
  buffer_load_dwordx4 v[16:19], v25, s[40:43], s28 offen
  buffer_load_dwordx4 v[20:23], v25, s[40:43], s28 offen offset:1024
  s_add_u32 s48, s36, 42213376
  s_addc_u32 s49, s37, 0
  s_load_dword s3, s[48:49], 0
  v_lshrrev_b32 v24, 2, v27
  v_lshlrev_b32 v24, 12, v24
  v_and_b32 v27, 3, v27
  v_lshl_add_u32 v24, v27, 8, v24
  v_lshl_add_u32 v24, v26, 4, v24
  v_lshlrev_b32 v26, 6, v26
  v_add_u32 v26, 147456, v26
  v_lshrrev_b32 v1, 6, v0
  v_and_b32 v0, 63, v0
  v_readfirstlane_b32 s25, v1
  v_lshl_add_u32 v25, v1, 3, v26
  s_and_b32 s29, s25, 3
  s_lshr_b32 s30, s25, 2
  v_lshlrev_b32 v9, 4, v0
  v_and_b32 v10, 7, v0
  v_bfe_u32 v11, v0, 4, 1
  s_and_b32 s28, s29, 1
  s_lshl_b32 s28, s28, 2
  v_lshl_or_b32 v11, v11, 1, s28
  v_xor_b32 v10, v10, v11
  v_lshlrev_b32 v10, 4, v10
  v_lshrrev_b32 v11, 3, v0
  s_lshl_b32 s28, s29, 3
  v_add_u32 v11, s28, v11
  s_movk_i32 s28, 6144
  v_mad_u32_u24 v8, v11, s28, v10
  s_movk_i32 s28, 7168
  v_mad_u32_u24 v7, v11, s28, v10
  s_mul_i32 s96, s23, 7
  s_lshl_b32 s28, s27, 1
  s_add_u32 s96, s96, s28
  s_lshl_b32 s97, s23, 1
  s_and_b32 s28, s27, 1
  s_add_u32 s97, s97, s28
  s_lshr_b32 s28, s27, 1
  s_lshl_b32 s28, s28, 4
  s_add_u32 s97, s97, s28
  v_lshlrev_b32 v12, 2, v0
  v_add_u32 v12, 163328, v12
  v_mov_b32 v13, 0
  ds_write_b32 v12, v13
  s_lshl_b32 s28, s29, 12
  v_add_u32 v2, s28, v9
  v_lshrrev_b32 v12, 4, v0
  v_bfe_u32 v13, v0, 2, 2
  v_lshl_add_u32 v12, v12, 3, v13
  v_lshlrev_b32 v12, 7, v12
  v_bfe_u32 v13, v0, 3, 2
  s_lshl_b32 s28, s30, 1
  v_xor_b32 v13, s28, v13
  v_lshl_add_u32 v12, v13, 5, v12
  v_and_b32 v13, 3, v0
  v_lshl_add_u32 v12, v13, 3, v12
  v_add_u32 v3, 65536, v12
  v_xor_b32 v4, 32, v3
  v_add_u32 v5, 40960, v3
  v_add_u32 v6, 40960, v4
  s_add_u32 s16, s36, 0
  s_addc_u32 s17, s37, 0
  s_mov_b32 s18, 4194304
  s_mov_b32 s19, 0x20000
  s_lshl_b32 s28, s96, 7
  s_sub_u32 s31, 7340032, s28
  s_add_u32 s4, s32, s28
  s_addc_u32 s5, s33, 0
  s_mov_b32 s6, s31
  s_mov_b32 s7, 0x20000
  s_add_u32 s8, s34, s28
  s_addc_u32 s9, s35, 0
  s_mov_b32 s10, s31
  s_mov_b32 s11, 0x20000
  s_lshl_b32 s28, s23, 8
  s_add_u32 s28, s28, 4096
  s_sub_u32 s31, 6291456, s28
  s_add_u32 s44, s12, s28
  s_addc_u32 s45, s13, 0
  s_mov_b32 s46, s31
  s_mov_b32 s47, 0x20000
  s_lshl_b32 s28, s97, 7
  s_sub_u32 s31, 6291456, s28
  s_add_u32 s12, s12, s28
  s_addc_u32 s13, s13, 0
  s_mov_b32 s14, s31
  s_mov_b32 s15, 0x20000
  s_cmp_ge_u32 s25, 4
  s_cbranch_scc1 mega_x
  s_mov_b32 s20, 0
  s_mov_b32 s21, 0
  s_lshl_b32 s22, s29, 10
  s_lshl_b32 s50, s2, 13
  s_add_u32 s31, s50, 8192
  s_mov_b32 s54, s31
  s_mov_b32 s55, 0x20000
  s_lshl_b32 s28, s29, 10
  s_add_u32 s50, s50, s28
  s_add_u32 s56, s36, 62914560
  s_addc_u32 s57, s37, 0
  s_mov_b32 s58, 2097152
  s_mov_b32 s59, 0x20000
  v_lshrrev_b32 v14, 3, v0
  v_lshlrev_b32 v14, 17, v14
  v_and_b32 v15, 7, v0
  v_lshl_add_u32 v14, v15, 4, v14
  s_and_b32 s62, s29, 1
  s_lshl_b32 s62, s62, 20
  s_and_b32 s28, s2, 31
  s_lshr_b32 s31, s2, 6
  s_lshl_b32 s31, s31, 5
  s_add_u32 s28, s28, s31
  s_and_b32 s31, s2, 32
  s_lshl_b32 s31, s31, 2
  s_add_u32 s28, s28, s31
  s_lshl_b32 s28, s28, 2
  s_lshr_b32 s31, s29, 1
  s_add_u32 s28, s28, s31
  s_lshl_b32 s28, s28, 7
  s_add_u32 s62, s62, s28
  s_sub_u32 s62, s62, 256
  s_cmp_eq_u32 s27, 3
  s_cbranch_scc1 mega_wC0
  s_add_u32 m0, s22, 65536
  s_nop 0
  buffer_load_dwordx4 v7, s[4:7], s20 offen offset:0 nt lds
  s_add_u32 m0, s22, 69504
  s_nop 0
  buffer_load_dwordx4 v7, s[4:7], s20 offen offset:128 nt lds
  s_add_u32 m0, s22, 73728
  s_nop 0
  buffer_load_dwordx4 v7, s[8:11], s20 offen offset:0 nt lds
  s_add_u32 m0, s22, 77696
  s_nop 0
  buffer_load_dwordx4 v7, s[8:11], s20 offen offset:128 nt lds
  s_add_u32 m0, s22, 81920
  s_nop 0
  buffer_load_dwordx4 v8, s[12:15], s21 offen offset:0 nt lds
  s_add_u32 s20, s20, 229376
  s_add_u32 s21, s21, 196608
  s_add_u32 m0, s22, 86016
  s_nop 0
  buffer_load_dwordx4 v7, s[4:7], s20 offen offset:0 nt lds
  s_add_u32 m0, s22, 89984
  s_nop 0
  buffer_load_dwordx4 v7, s[4:7], s20 offen offset:128 nt lds
  s_add_u32 m0, s22, 94208
  s_nop 0
  buffer_load_dwordx4 v7, s[8:11], s20 offen offset:0 nt lds
  s_add_u32 m0, s22, 98176
  s_nop 0
  buffer_load_dwordx4 v7, s[8:11], s20 offen offset:128 nt lds
  s_add_u32 m0, s22, 102400
  s_nop 0
  buffer_load_dwordx4 v8, s[12:15], s21 offen offset:0 nt lds
  s_add_u32 s20, s20, 229376
  s_add_u32 s21, s21, 196608
  s_waitcnt vmcnt(10)
  s_branch mega_ln
mega_wC0:
  s_add_u32 m0, s22, 65536
  s_nop 0
  buffer_load_dwordx4 v7, s[4:7], s20 offen offset:0 nt lds
  s_add_u32 m0, s22, 69632
  s_nop 0
  buffer_load_dwordx4 v8, s[44:47], s21 offen offset:0 nt lds
  s_add_u32 m0, s22, 73728
  s_nop 0
  buffer_load_dwordx4 v7, s[8:11], s20 offen offset:0 nt lds
  s_add_u32 m0, s22, 77696
  s_nop 0
  buffer_load_dwordx4 v8, s[44:47], s21 offen offset:128 nt lds
  s_add_u32 m0, s22, 81920
  s_nop 0
  buffer_load_dwordx4 v8, s[12:15], s21 offen offset:0 nt lds
  s_add_u32 s20, s20, 229376
  s_add_u32 s21, s21, 196608
  s_add_u32 m0, s22, 86016
  s_nop 0
  buffer_load_dwordx4 v7, s[4:7], s20 offen offset:0 nt lds
  s_add_u32 m0, s22, 90112
  s_nop 0
  buffer_load_dwordx4 v8, s[44:47], s21 offen offset:0 nt lds
  s_add_u32 m0, s22, 94208
  s_nop 0
  buffer_load_dwordx4 v7, s[8:11], s20 offen offset:0 nt lds
  s_add_u32 m0, s22, 98176
  s_nop 0
  buffer_load_dwordx4 v8, s[44:47], s21 offen offset:128 nt lds
  s_add_u32 m0, s22, 102400
  s_nop 0
  buffer_load_dwordx4 v8, s[12:15], s21 offen offset:0 nt lds
  s_add_u32 s20, s20, 229376
  s_add_u32 s21, s21, 196608
  s_waitcnt vmcnt(10)
  s_branch mega_ln
mega_x:
  s_lshl_b32 s20, s26, 2
  s_add_u32 s20, s20, s29
  s_lshl_b32 s20, s20, 17
  s_lshl_b32 s22, s29, 12
  s_mul_i32 s50, s2, 28672
  s_add_u32 s31, s50, 28672
  s_mov_b32 s52, s56
  s_mov_b32 s53, s57
  s_mov_b32 s54, s31
  s_mov_b32 s55, 0x20000
  s_lshl_b32 s28, s29, 10
  s_add_u32 s50, s50, s28
  s_add_u32 s56, s36, 54525952
  s_addc_u32 s57, s37, 0
  s_mov_b32 s58, 7340032
  s_mov_b32 s59, 0x20000
  v_lshrrev_b32 v14, 3, v0
  s_mov_b32 s28, 458752
  v_and_b32 v15, 7, v0
  v_lshlrev_b32 v15, 4, v15
  v_mad_u32_u24 v14, v14, s28, v15
  s_and_b32 s62, s29, 1
  s_mul_i32 s62, s62, 3670016
  s_mul_i32 s28, s2, 14
  s_lshr_b32 s31, s29, 1
  s_add_u32 s28, s28, s31
  s_lshl_b32 s28, s28, 7
  s_add_u32 s62, s62, s28
  s_add_u32 s32, s36, 41943040
  s_addc_u32 s33, s37, 0
  s_mov_b32 s34, 270464
  s_mov_b32 s35, 0x20000
  s_lshl_b32 s28, s26, 2
  s_add_u32 s28, s28, s29
  s_lshl_b32 s28, s28, 10
  s_add_u32 s28, s28, 204800
  v_and_b32 v27, 7, v0
  v_lshlrev_b32 v27, 7, v27
  buffer_load_dword v1, v27, s[32:35], s28 offen sc1
  s_lshl_b32 s28, s2, 2
  s_add_u32 s28, s28, s29
  s_lshl_b32 s28, s28, 8
  v_and_b32 v27, 1, v0
  v_lshlrev_b32 v27, 7, v27
  buffer_load_dword v1, v27, s[32:35], s28 offen sc1
  s_getpc_b64 s[32:33]
mega_pc:
  s_sub_u32 s32, s32, mega_pc-mega_kernel
  s_subb_u32 s33, s33, 0
  s_mov_b32 s34, mega_end-mega_kernel
  s_mov_b32 s35, 0x20000
  s_lshr_b32 s28, s2, 3
  s_lshl_b32 s28, s28, 2
  s_add_u32 s28, s28, s29
  s_lshl_b32 s28, s28, 9
  v_lshlrev_b32 v27, 3, v0
  buffer_load_dword v1, v27, s[32:35], s28 offen
  s_waitcnt vmcnt(3)
mega_ln:
  s_lshr_b32 s40, s61, 3
  s_lshl_b32 s40, s40, 17
  s_bfe_u32 s41, s61, 0x20001
  s_lshl_b32 s41, s41, 10
  s_add_u32 s40, s40, s41
  s_and_b32 s41, s61, 1
  s_lshl_b32 s41, s41, 7
  s_add_u32 s40, s40, s41
  s_add_u32 s41, s40, 65536
  s_mov_b32 s42, 0xffff0000
  v_lshlrev_b32 v44, 16, v16
  v_and_b32 v45, s42, v16
  v_lshlrev_b32 v46, 16, v17
  v_and_b32 v47, s42, v17
  v_lshlrev_b32 v48, 16, v18
  v_and_b32 v49, s42, v18
  v_lshlrev_b32 v50, 16, v19
  v_and_b32 v51, s42, v19
  v_lshlrev_b32 v52, 16, v20
  v_and_b32 v53, s42, v20
  v_lshlrev_b32 v54, 16, v21
  v_and_b32 v55, s42, v21
  v_lshlrev_b32 v56, 16, v22
  v_and_b32 v57, s42, v22
  v_lshlrev_b32 v58, 16, v23
  v_and_b32 v59, s42, v23
  v_pk_add_f32 v[28:29], v[44:45], v[52:53]
  v_pk_add_f32 v[30:31], v[46:47], v[54:55]
  v_pk_add_f32 v[32:33], v[48:49], v[56:57]
  v_pk_add_f32 v[34:35], v[50:51], v[58:59]
  v_pk_add_f32 v[28:29], v[28:29], v[30:31]
  v_pk_add_f32 v[32:33], v[32:33], v[34:35]
  v_pk_add_f32 v[28:29], v[28:29], v[32:33]
  v_add_f32 v28, v28, v29
  s_nop 1
  v_add_f32_dpp v28, v28, v28 row_ror:8 row_mask:0xf bank_mask:0xf
  v_mov_b32 v30, v28
  s_nop 1
  v_permlane16_swap_b32 v28, v30
  v_add_f32 v28, v28, v30
  v_mov_b32 v30, v28
  s_nop 1
  v_permlane32_swap_b32 v28, v30
  v_add_f32 v28, v28, v30
  v_mul_f32 v28, 0x3c000000, v28
  v_pk_add_f32 v[60:61], v[44:45], v[28:29] op_sel_hi:[1,0] neg_lo:[0,1] neg_hi:[0,1]
  v_pk_add_f32 v[62:63], v[46:47], v[28:29] op_sel_hi:[1,0] neg_lo:[0,1] neg_hi:[0,1]
  v_pk_add_f32 v[64:65], v[48:49], v[28:29] op_sel_hi:[1,0] neg_lo:[0,1] neg_hi:[0,1]
  v_pk_add_f32 v[66:67], v[50:51], v[28:29] op_sel_hi:[1,0] neg_lo:[0,1] neg_hi:[0,1]
  v_pk_add_f32 v[68:69], v[52:53], v[28:29] op_sel_hi:[1,0] neg_lo:[0,1] neg_hi:[0,1]
  v_pk_add_f32 v[70:71], v[54:55], v[28:29] op_sel_hi:[1,0] neg_lo:[0,1] neg_hi:[0,1]
  v_pk_add_f32 v[72:73], v[56:57], v[28:29] op_sel_hi:[1,0] neg_lo:[0,1] neg_hi:[0,1]
  v_pk_add_f32 v[74:75], v[58:59], v[28:29] op_sel_hi:[1,0] neg_lo:[0,1] neg_hi:[0,1]
  v_pk_mul_f32 v[32:33], v[60:61], v[60:61]
  v_pk_mul_f32 v[34:35], v[62:63], v[62:63]
  v_pk_fma_f32 v[32:33], v[64:65], v[64:65], v[32:33]
  v_pk_fma_f32 v[34:35], v[66:67], v[66:67], v[34:35]
  v_pk_fma_f32 v[32:33], v[68:69], v[68:69], v[32:33]
  v_pk_fma_f32 v[34:35], v[70:71], v[70:71], v[34:35]
  v_pk_fma_f32 v[32:33], v[72:73], v[72:73], v[32:33]
  v_pk_fma_f32 v[34:35], v[74:75], v[74:75], v[34:35]
  v_pk_add_f32 v[32:33], v[32:33], v[34:35]
  v_add_f32 v29, v32, v33
  s_nop 1
  v_add_f32_dpp v29, v29, v29 row_ror:8 row_mask:0xf bank_mask:0xf
  v_mov_b32 v30, v29
  s_nop 1
  v_permlane16_swap_b32 v29, v30
  v_add_f32 v29, v29, v30
  v_mov_b32 v30, v29
  s_nop 1
  v_permlane32_swap_b32 v29, v30
  v_add_f32 v29, v29, v30
  ds_write_b64 v25, v[28:29]
  s_waitcnt lgkmcnt(0)
  s_barrier
  ds_read_b128 v[60:63], v26 offset:0
  ds_read_b128 v[64:67], v26 offset:16
  ds_read_b128 v[68:71], v26 offset:32
  ds_read_b128 v[72:75], v26 offset:48
  s_waitcnt lgkmcnt(0)
  v_add_f32 v28, v60, v62
  v_add_f32 v29, v64, v66
  v_add_f32 v30, v68, v70
  v_add_f32 v31, v72, v74
  v_add_f32 v32, v61, v63
  v_add_f32 v33, v65, v67
  v_add_f32 v34, v69, v71
  v_add_f32 v35, v73, v75
  v_add_f32 v28, v28, v29
  v_add_f32 v30, v30, v31
  v_add_f32 v32, v32, v33
  v_add_f32 v34, v34, v35
  v_add_f32 v28, v28, v30
  v_add_f32 v32, v32, v34
  v_mul_f32 v28, 0x3e000000, v28
  v_sub_f32 v60, v60, v28
  v_sub_f32 v62, v62, v28
  v_sub_f32 v64, v64, v28
  v_sub_f32 v66, v66, v28
  v_sub_f32 v68, v68, v28
  v_sub_f32 v70, v70, v28
  v_sub_f32 v72, v72, v28
  v_sub_f32 v74, v74, v28
  v_mul_f32 v33, v60, v60
  v_mul_f32 v34, v62, v62
  v_fmac_f32 v33, v64, v64
  v_fmac_f32 v34, v66, v66
  v_fmac_f32 v33, v68, v68
  v_fmac_f32 v34, v70, v70
  v_fmac_f32 v33, v72, v72
  v_fmac_f32 v34, v74, v74
  v_add_f32 v33, v33, v34
  v_mul_f32 v32, 0x3a800000, v32
  v_fmac_f32 v32, 0x3e000000, v33
  v_cvt_pk_bf16_f32 v30, v28, v32
  v_lshlrev_b32 v28, 16, v30
  v_and_b32 v29, s42, v30
  v_add_f32 v29, 0x3727c5ac, v29
  v_cvt_pk_bf16_f32 v29, v29, v29
  v_and_b32 v29, s42, v29
  v_sqrt_f32 v29, v29
  s_nop 0
  v_pk_add_f32 v[44:45], v[44:45], v[28:29] op_sel_hi:[1,0] neg_lo:[0,1] neg_hi:[0,1]
  v_pk_add_f32 v[46:47], v[46:47], v[28:29] op_sel_hi:[1,0] neg_lo:[0,1] neg_hi:[0,1]
  v_pk_add_f32 v[48:49], v[48:49], v[28:29] op_sel_hi:[1,0] neg_lo:[0,1] neg_hi:[0,1]
  v_pk_add_f32 v[50:51], v[50:51], v[28:29] op_sel_hi:[1,0] neg_lo:[0,1] neg_hi:[0,1]
  v_pk_add_f32 v[52:53], v[52:53], v[28:29] op_sel_hi:[1,0] neg_lo:[0,1] neg_hi:[0,1]
  v_pk_add_f32 v[54:55], v[54:55], v[28:29] op_sel_hi:[1,0] neg_lo:[0,1] neg_hi:[0,1]
  v_pk_add_f32 v[56:57], v[56:57], v[28:29] op_sel_hi:[1,0] neg_lo:[0,1] neg_hi:[0,1]
  v_pk_add_f32 v[58:59], v[58:59], v[28:29] op_sel_hi:[1,0] neg_lo:[0,1] neg_hi:[0,1]
  v_cvt_pk_bf16_f32 v29, v29, v29
  v_and_b32 v29, s42, v29
  v_rcp_f32 v32, v29
  v_cvt_pk_bf16_f32 v44, v44, v45
  v_cvt_pk_bf16_f32 v46, v46, v47
  v_cvt_pk_bf16_f32 v48, v48, v49
  v_cvt_pk_bf16_f32 v50, v50, v51
  v_and_b32 v45, s42, v44
  v_lshlrev_b32 v44, 16, v44
  v_and_b32 v47, s42, v46
  v_lshlrev_b32 v46, 16, v46
  v_and_b32 v49, s42, v48
  v_lshlrev_b32 v48, 16, v48
  v_and_b32 v51, s42, v50
  v_lshlrev_b32 v50, 16, v50
  v_pk_mul_f32 v[44:45], v[44:45], v[32:33] op_sel_hi:[1,0]
  v_pk_mul_f32 v[46:47], v[46:47], v[32:33] op_sel_hi:[1,0]
  v_pk_mul_f32 v[48:49], v[48:49], v[32:33] op_sel_hi:[1,0]
  v_pk_mul_f32 v[50:51], v[50:51], v[32:33] op_sel_hi:[1,0]
  v_cvt_pk_bf16_f32 v16, v44, v45
  v_cvt_pk_bf16_f32 v17, v46, v47
  v_cvt_pk_bf16_f32 v18, v48, v49
  v_cvt_pk_bf16_f32 v19, v50, v51
  buffer_store_dwordx4 v[16:19], v24, s[16:19], s40 offen sc1
  v_cvt_pk_bf16_f32 v52, v52, v53
  v_cvt_pk_bf16_f32 v54, v54, v55
  v_cvt_pk_bf16_f32 v56, v56, v57
  v_cvt_pk_bf16_f32 v58, v58, v59
  v_and_b32 v53, s42, v52
  v_lshlrev_b32 v52, 16, v52
  v_and_b32 v55, s42, v54
  v_lshlrev_b32 v54, 16, v54
  v_and_b32 v57, s42, v56
  v_lshlrev_b32 v56, 16, v56
  v_and_b32 v59, s42, v58
  v_lshlrev_b32 v58, 16, v58
  v_pk_mul_f32 v[52:53], v[52:53], v[32:33] op_sel_hi:[1,0]
  v_pk_mul_f32 v[54:55], v[54:55], v[32:33] op_sel_hi:[1,0]
  v_pk_mul_f32 v[56:57], v[56:57], v[32:33] op_sel_hi:[1,0]
  v_pk_mul_f32 v[58:59], v[58:59], v[32:33] op_sel_hi:[1,0]
  v_cvt_pk_bf16_f32 v20, v52, v53
  v_cvt_pk_bf16_f32 v21, v54, v55
  v_cvt_pk_bf16_f32 v22, v56, v57
  v_cvt_pk_bf16_f32 v23, v58, v59
  buffer_store_dwordx4 v[20:23], v24, s[16:19], s41 offen sc1
  s_mul_i32 s3, s3, 0x9e3779b1
  s_add_u32 s3, s3, 0x7f4a7c15
  s_add_u32 s40, s36, 41943040
  s_addc_u32 s41, s37, 0
  s_mov_b32 s42, 270464
  s_mov_b32 s43, 0x20000
  s_lshl_b32 s28, s61, 7
  s_add_u32 s28, s28, 204800
  v_mov_b64 v[96:97], 0
  v_mov_b64 v[98:99], 0
  v_mov_b64 v[100:101], 0
  v_mov_b64 v[102:103], 0
  v_mov_b64 v[104:105], 0
  v_mov_b64 v[106:107], 0
  v_mov_b64 v[108:109], 0
  v_mov_b64 v[110:111], 0
  v_mov_b64 v[112:113], 0
  v_mov_b64 v[114:115], 0
  v_mov_b64 v[116:117], 0
  v_mov_b64 v[118:119], 0
  v_mov_b64 v[120:121], 0
  v_mov_b64 v[122:123], 0
  v_mov_b64 v[124:125], 0
  v_mov_b64 v[126:127], 0
  v_mov_b64 v[128:129], 0
  v_mov_b64 v[130:131], 0
  v_mov_b64 v[132:133], 0
  v_mov_b64 v[134:135], 0
  v_mov_b64 v[136:137], 0
  v_mov_b64 v[138:139], 0
  v_mov_b64 v[140:141], 0
  v_mov_b64 v[142:143], 0
  v_mov_b64 v[144:145], 0
  v_mov_b64 v[146:147], 0
  v_mov_b64 v[148:149], 0
  v_mov_b64 v[150:151], 0
  v_mov_b64 v[152:153], 0
  v_mov_b64 v[154:155], 0
  v_mov_b64 v[156:157], 0
  v_mov_b64 v[158:159], 0
  v_mov_b64 v[160:161], 0
  v_mov_b64 v[162:163], 0
  v_mov_b64 v[164:165], 0
  v_mov_b64 v[166:167], 0
  v_mov_b64 v[168:169], 0
  v_mov_b64 v[170:171], 0
  v_mov_b64 v[172:173], 0
  v_mov_b64 v[174:175], 0
  v_mov_b64 v[176:177], 0
  v_mov_b64 v[178:179], 0
  v_mov_b64 v[180:181], 0
  v_mov_b64 v[182:183], 0
  v_mov_b64 v[184:185], 0
  v_mov_b64 v[186:187], 0
  v_mov_b64 v[188:189], 0
  v_mov_b64 v[190:191], 0
  v_mov_b64 v[192:193], 0
  v_mov_b64 v[194:195], 0
  v_mov_b64 v[196:197], 0
  v_mov_b64 v[198:199], 0
  v_mov_b64 v[200:201], 0
  v_mov_b64 v[202:203], 0
  v_mov_b64 v[204:205], 0
  v_mov_b64 v[206:207], 0
  v_mov_b64 v[208:209], 0
  v_mov_b64 v[210:211], 0
  v_mov_b64 v[212:213], 0
  v_mov_b64 v[214:215], 0
  v_mov_b64 v[216:217], 0
  v_mov_b64 v[218:219], 0
  v_mov_b64 v[220:221], 0
  v_mov_b64 v[222:223], 0
  v_mov_b64 v[224:225], 0
  v_mov_b64 v[226:227], 0
  v_mov_b64 v[228:229], 0
  v_mov_b64 v[230:231], 0
  v_mov_b64 v[232:233], 0
  v_mov_b64 v[234:235], 0
  v_mov_b64 v[236:237], 0
  v_mov_b64 v[238:239], 0
  v_mov_b64 v[240:241], 0
  v_mov_b64 v[242:243], 0
  v_mov_b64 v[244:245], 0
  v_mov_b64 v[246:247], 0
  v_mov_b64 v[248:249], 0
  v_mov_b64 v[250:251], 0
  v_mov_b64 v[252:253], 0
  v_mov_b64 v[254:255], 0
  s_waitcnt vmcnt(0)
  s_barrier
  s_cmp_lg_u32 s25, 0
  s_cbranch_scc1 mega_nofx
  s_mov_b32 exec_lo, -1
  s_mov_b32 exec_hi, 0
  v_lshlrev_b32 v24, 2, v0
  v_mov_b32 v25, s3
  buffer_store_dword v25, v24, s[40:43], s28 offen sc1
  s_mov_b64 exec, -1
mega_nofx:
  s_cmp_lt_u32 s25, 4
  s_cbranch_scc1 mega_w
  s_lshl_b32 s28, s26, 2
  s_add_u32 s28, s28, s29
  s_lshl_b32 s28, s28, 10
  s_add_u32 s28, s28, 204800
  v_and_b32 v24, 7, v0
  v_lshlrev_b32 v24, 7, v24
  s_mov_b32 s31, 1048576
mega_fx_poll:
  buffer_load_dword v25, v24, s[40:43], s28 offen sc1
  s_waitcnt vmcnt(0)
mega_fx_chk:
  v_cmp_ne_u32 vcc, s3, v25
  s_cbranch_vccz mega_fx_ok
  s_mov_b64 exec, vcc
  s_sleep 2
  s_sub_u32 s31, s31, 1
  s_cmp_lg_u32 s31, 0
  s_cbranch_scc1 mega_fx_poll
mega_fx_ok:
  s_mov_b64 exec, -1
  s_cmp_eq_u32 s27, 3
  s_cbranch_scc1 mega_xC
  s_add_u32 m0, s22, 0
  s_nop 0
  buffer_load_dwordx4 v9, s[16:19], s20 offen offset:0 sc1 lds
  buffer_load_dwordx4 v9, s[16:19], s20 offen offset:1024 sc1 lds
  buffer_load_dwordx4 v9, s[16:19], s20 offen offset:2048 sc1 lds
  buffer_load_dwordx4 v9, s[16:19], s20 offen offset:3072 sc1 lds
  s_add_u32 s20, s20, 4096
  s_add_u32 m0, s22, 16384
  s_nop 0
  buffer_load_dwordx4 v9, s[16:19], s20 offen offset:0 sc1 lds
  buffer_load_dwordx4 v9, s[16:19], s20 offen offset:1024 sc1 lds
  buffer_load_dwordx4 v9, s[16:19], s20 offen offset:2048 sc1 lds
  buffer_load_dwordx4 v9, s[16:19], s20 offen offset:3072 sc1 lds
  s_add_u32 s20, s20, 4096
  s_add_u32 m0, s22, 32768
  s_nop 0
  buffer_load_dwordx4 v9, s[16:19], s20 offen offset:0 sc1 lds
  buffer_load_dwordx4 v9, s[16:19], s20 offen offset:1024 sc1 lds
  buffer_load_dwordx4 v9, s[16:19], s20 offen offset:2048 sc1 lds
  buffer_load_dwordx4 v9, s[16:19], s20 offen offset:3072 sc1 lds
  s_add_u32 s20, s20, 4096
  s_mov_b32 s31, 0x7f000000
  buffer_load_dword v1, v9, s[52:55], s31 offen
  s_waitcnt vmcnt(9)
  s_barrier
  ds_read_b64_tr_b16 v[76:77], v3 offset:0
  ds_read_b64_tr_b16 v[78:79], v3 offset:512
  ds_read_b128 v[44:47], v2 offset:0
  ds_read_b128 v[48:51], v2 offset:1024
  ds_read_b64_tr_b16 v[80:81], v4 offset:0
  ds_read_b64_tr_b16 v[82:83], v4 offset:512
  ds_read_b128 v[52:55], v2 offset:2048
  ds_read_b128 v[56:59], v2 offset:3072
  ds_read_b64_tr_b16 v[84:85], v3 offset:4096
  ds_read_b64_tr_b16 v[86:87], v3 offset:4608
  ds_read_b64_tr_b16 v[88:89], v4 offset:4096
  ds_read_b64_tr_b16 v[90:91], v4 offset:4608
  s_mul_i32 s35, s2, 224
  s_mov_b32 s24, 8
.p2align 6
k2_loop_Ax:
  s_waitcnt lgkmcnt(4)
  v_mfma_f32_16x16x32_bf16 v[96:99], v[76:79], v[44:47], v[96:99]
  ds_read_b64_tr_b16 v[92:93], v3 offset:8192
  v_mfma_f32_16x16x32_bf16 v[100:103], v[76:79], v[48:51], v[100:103]
  ds_read_b64_tr_b16 v[94:95], v3 offset:8704
  v_mfma_f32_16x16x32_bf16 v[104:107], v[76:79], v[52:55], v[104:107]
  v_mfma_f32_16x16x32_bf16 v[108:111], v[76:79], v[56:59], v[108:111]
  v_mfma_f32_16x16x32_bf16 v[124:127], v[80:83], v[56:59], v[124:127]
  ds_read_b64_tr_b16 v[76:77], v4 offset:8192
  v_mfma_f32_16x16x32_bf16 v[120:123], v[80:83], v[52:55], v[120:123]
  ds_read_b64_tr_b16 v[78:79], v4 offset:8704
  v_mfma_f32_16x16x32_bf16 v[116:119], v[80:83], v[48:51], v[116:119]
  v_mfma_f32_16x16x32_bf16 v[112:115], v[80:83], v[44:47], v[112:115]
  s_waitcnt lgkmcnt(6)
  v_mfma_f32_16x16x32_bf16 v[128:131], v[84:87], v[44:47], v[128:131]
  ds_read_b64_tr_b16 v[80:81], v3 offset:12288
  v_mfma_f32_16x16x32_bf16 v[132:135], v[84:87], v[48:51], v[132:135]
  ds_read_b64_tr_b16 v[82:83], v3 offset:12800
  v_mfma_f32_16x16x32_bf16 v[136:139], v[84:87], v[52:55], v[136:139]
  v_mfma_f32_16x16x32_bf16 v[140:143], v[84:87], v[56:59], v[140:143]
  s_waitcnt lgkmcnt(6)
  v_mfma_f32_16x16x32_bf16 v[156:159], v[88:91], v[56:59], v[156:159]
  ds_read_b64_tr_b16 v[84:85], v4 offset:12288
  v_mfma_f32_16x16x32_bf16 v[152:155], v[88:91], v[52:55], v[152:155]
  ds_read_b64_tr_b16 v[86:87], v4 offset:12800
  v_mfma_f32_16x16x32_bf16 v[148:151], v[88:91], v[48:51], v[148:151]
  v_mfma_f32_16x16x32_bf16 v[144:147], v[88:91], v[44:47], v[144:147]
  s_waitcnt lgkmcnt(6)
  v_mfma_f32_16x16x32_bf16 v[160:163], v[92:95], v[44:47], v[160:163]
  ds_read_b64_tr_b16 v[88:89], v3 offset:16384
  v_mfma_f32_16x16x32_bf16 v[164:167], v[92:95], v[48:51], v[164:167]
  ds_read_b64_tr_b16 v[90:91], v3 offset:16896
  v_mfma_f32_16x16x32_bf16 v[168:171], v[92:95], v[52:55], v[168:171]
  v_mfma_f32_16x16x32_bf16 v[172:175], v[92:95], v[56:59], v[172:175]
  s_waitcnt lgkmcnt(6)
  v_mfma_f32_16x16x32_bf16 v[188:191], v[76:79], v[56:59], v[188:191]
  ds_read_b64_tr_b16 v[92:93], v4 offset:16384
  v_mfma_f32_16x16x32_bf16 v[184:187], v[76:79], v[52:55], v[184:187]
  ds_read_b64_tr_b16 v[94:95], v4 offset:16896
  v_mfma_f32_16x16x32_bf16 v[180:183], v[76:79], v[48:51], v[180:183]
  v_mfma_f32_16x16x32_bf16 v[176:179], v[76:79], v[44:47], v[176:179]
  s_waitcnt vmcnt(5) lgkmcnt(6)
  s_barrier
  s_add_u32 m0, s22, 49152
  s_nop 0
  buffer_load_dwordx4 v9, s[16:19], s20 offen offset:0 sc1 lds
  buffer_load_dwordx4 v9, s[16:19], s20 offen offset:1024 sc1 lds
  buffer_load_dwordx4 v9, s[16:19], s20 offen offset:2048 sc1 lds
  buffer_load_dwordx4 v9, s[16:19], s20 offen offset:3072 sc1 lds
  s_add_u32 s20, s20, 4096
  s_cmp_eq_u32 s24, 1
  s_cselect_b32 s20, 0x7f000000, s20
  buffer_load_dwordx4 v[16:19], v9, s[52:55], s50 offen nt
  s_add_u32 s50, s50, 4096
  v_mfma_f32_16x16x32_bf16 v[192:195], v[80:83], v[44:47], v[192:195]
  ds_read_b64_tr_b16 v[76:77], v3 offset:20480
  v_mfma_f32_16x16x32_bf16 v[196:199], v[80:83], v[48:51], v[196:199]
  ds_read_b64_tr_b16 v[78:79], v3 offset:20992
  v_mfma_f32_16x16x32_bf16 v[200:203], v[80:83], v[52:55], v[200:203]
  ds_read_b128 v[60:63], v2 offset:16384
  v_mfma_f32_16x16x32_bf16 v[204:207], v[80:83], v[56:59], v[204:207]
  ds_read_b128 v[64:67], v2 offset:17408
  s_waitcnt lgkmcnt(8)
  v_mfma_f32_16x16x32_bf16 v[220:223], v[84:87], v[56:59], v[220:223]
  ds_read_b64_tr_b16 v[80:81], v4 offset:20480
  v_mfma_f32_16x16x32_bf16 v[216:219], v[84:87], v[52:55], v[216:219]
  ds_read_b64_tr_b16 v[82:83], v4 offset:20992
  v_mfma_f32_16x16x32_bf16 v[212:215], v[84:87], v[48:51], v[212:215]
  ds_read_b128 v[68:71], v2 offset:18432
  v_mfma_f32_16x16x32_bf16 v[208:211], v[84:87], v[44:47], v[208:211]
  ds_read_b128 v[72:75], v2 offset:19456
  s_waitcnt lgkmcnt(10)
  v_mfma_f32_16x16x32_bf16 v[224:227], v[88:91], v[44:47], v[224:227]
  ds_read_b64_tr_b16 v[84:85], v3 offset:24576
  v_mfma_f32_16x16x32_bf16 v[228:231], v[88:91], v[48:51], v[228:231]
  ds_read_b64_tr_b16 v[86:87], v3 offset:25088
  v_mfma_f32_16x16x32_bf16 v[232:235], v[88:91], v[52:55], v[232:235]
  v_mfma_f32_16x16x32_bf16 v[236:239], v[88:91], v[56:59], v[236:239]
  s_waitcnt lgkmcnt(10)
  v_mfma_f32_16x16x32_bf16 v[252:255], v[92:95], v[56:59], v[252:255]
  ds_read_b64_tr_b16 v[88:89], v4 offset:24576
  v_mfma_f32_16x16x32_bf16 v[248:251], v[92:95], v[52:55], v[248:251]
  ds_read_b64_tr_b16 v[90:91], v4 offset:25088
  v_mfma_f32_16x16x32_bf16 v[244:247], v[92:95], v[48:51], v[244:247]
  v_mfma_f32_16x16x32_bf16 v[240:243], v[92:95], v[44:47], v[240:243]
  s_waitcnt lgkmcnt(4)
  v_mfma_f32_16x16x32_bf16 v[96:99], v[76:79], v[60:63], v[96:99]
  ds_read_b64_tr_b16 v[92:93], v3 offset:28672
  v_mfma_f32_16x16x32_bf16 v[100:103], v[76:79], v[64:67], v[100:103]
  ds_read_b64_tr_b16 v[94:95], v3 offset:29184
  v_mfma_f32_16x16x32_bf16 v[104:107], v[76:79], v[68:71], v[104:107]
  v_mfma_f32_16x16x32_bf16 v[108:111], v[76:79], v[72:75], v[108:111]
  v_mfma_f32_16x16x32_bf16 v[124:127], v[80:83], v[72:75], v[124:127]
  ds_read_b64_tr_b16 v[76:77], v4 offset:28672
  v_mfma_f32_16x16x32_bf16 v[120:123], v[80:83], v[68:71], v[120:123]
  ds_read_b64_tr_b16 v[78:79], v4 offset:29184
  v_mfma_f32_16x16x32_bf16 v[116:119], v[80:83], v[64:67], v[116:119]
  v_mfma_f32_16x16x32_bf16 v[112:115], v[80:83], v[60:63], v[112:115]
  s_waitcnt lgkmcnt(6)
  v_mfma_f32_16x16x32_bf16 v[128:131], v[84:87], v[60:63], v[128:131]
  ds_read_b64_tr_b16 v[80:81], v3 offset:32768
  v_mfma_f32_16x16x32_bf16 v[132:135], v[84:87], v[64:67], v[132:135]
  ds_read_b64_tr_b16 v[82:83], v3 offset:33280
  v_mfma_f32_16x16x32_bf16 v[136:139], v[84:87], v[68:71], v[136:139]
  v_mfma_f32_16x16x32_bf16 v[140:143], v[84:87], v[72:75], v[140:143]
  s_waitcnt lgkmcnt(6)
  v_mfma_f32_16x16x32_bf16 v[156:159], v[88:91], v[72:75], v[156:159]
  ds_read_b64_tr_b16 v[84:85], v4 offset:32768
  v_mfma_f32_16x16x32_bf16 v[152:155], v[88:91], v[68:71], v[152:155]
  ds_read_b64_tr_b16 v[86:87], v4 offset:33280
  v_mfma_f32_16x16x32_bf16 v[148:151], v[88:91], v[64:67], v[148:151]
  v_mfma_f32_16x16x32_bf16 v[144:147], v[88:91], v[60:63], v[144:147]
  s_waitcnt lgkmcnt(6)
  v_mfma_f32_16x16x32_bf16 v[160:163], v[92:95], v[60:63], v[160:163]
  ds_read_b64_tr_b16 v[88:89], v3 offset:36864
  v_mfma_f32_16x16x32_bf16 v[164:167], v[92:95], v[64:67], v[164:167]
  ds_read_b64_tr_b16 v[90:91], v3 offset:37376
  v_mfma_f32_16x16x32_bf16 v[168:171], v[92:95], v[68:71], v[168:171]
  v_mfma_f32_16x16x32_bf16 v[172:175], v[92:95], v[72:75], v[172:175]
  s_waitcnt lgkmcnt(6)
  v_mfma_f32_16x16x32_bf16 v[188:191], v[76:79], v[72:75], v[188:191]
  ds_read_b64_tr_b16 v[92:93], v4 offset:36864
  v_mfma_f32_16x16x32_bf16 v[184:187], v[76:79], v[68:71], v[184:187]
  ds_read_b64_tr_b16 v[94:95], v4 offset:37376
  v_mfma_f32_16x16x32_bf16 v[180:183], v[76:79], v[64:67], v[180:183]
  v_mfma_f32_16x16x32_bf16 v[176:179], v[76:79], v[60:63], v[176:179]
  s_waitcnt vmcnt(6) lgkmcnt(6)
  s_barrier
  s_add_u32 m0, s22, 0
  s_nop 0
  buffer_load_dwordx4 v9, s[16:19], s20 offen offset:0 sc1 lds
  buffer_load_dwordx4 v9, s[16:19], s20 offen offset:1024 sc1 lds
  buffer_load_dwordx4 v9, s[16:19], s20 offen offset:2048 sc1 lds
  buffer_load_dwordx4 v9, s[16:19], s20 offen offset:3072 sc1 lds
  s_add_u32 s20, s20, 4096
  v_mfma_f32_16x16x32_bf16 v[192:195], v[80:83], v[60:63], v[192:195]
  ds_read_b64_tr_b16 v[76:77], v5 offset:0
  v_mfma_f32_16x16x32_bf16 v[196:199], v[80:83], v[64:67], v[196:199]
  ds_read_b64_tr_b16 v[78:79], v5 offset:512
  v_mfma_f32_16x16x32_bf16 v[200:203], v[80:83], v[68:71], v[200:203]
  ds_read_b128 v[44:47], v2 offset:32768
  v_mfma_f32_16x16x32_bf16 v[204:207], v[80:83], v[72:75], v[204:207]
  ds_read_b128 v[48:51], v2 offset:33792
  s_waitcnt lgkmcnt(8)
  v_mfma_f32_16x16x32_bf16 v[220:223], v[84:87], v[72:75], v[220:223]
  ds_read_b64_tr_b16 v[80:81], v6 offset:0
  v_mfma_f32_16x16x32_bf16 v[216:219], v[84:87], v[68:71], v[216:219]
  ds_read_b64_tr_b16 v[82:83], v6 offset:512
  v_mfma_f32_16x16x32_bf16 v[212:215], v[84:87], v[64:67], v[212:215]
  ds_read_b128 v[52:55], v2 offset:34816
  v_mfma_f32_16x16x32_bf16 v[208:211], v[84:87], v[60:63], v[208:211]
  ds_read_b128 v[56:59], v2 offset:35840
  s_waitcnt lgkmcnt(10)
  v_mfma_f32_16x16x32_bf16 v[224:227], v[88:91], v[60:63], v[224:227]
  ds_read_b64_tr_b16 v[84:85], v5 offset:4096
  v_mfma_f32_16x16x32_bf16 v[228:231], v[88:91], v[64:67], v[228:231]
  ds_read_b64_tr_b16 v[86:87], v5 offset:4608
  v_mfma_f32_16x16x32_bf16 v[232:235], v[88:91], v[68:71], v[232:235]
  v_mfma_f32_16x16x32_bf16 v[236:239], v[88:91], v[72:75], v[236:239]
  s_waitcnt lgkmcnt(10)
  v_mfma_f32_16x16x32_bf16 v[252:255], v[92:95], v[72:75], v[252:255]
  ds_read_b64_tr_b16 v[88:89], v6 offset:4096
  v_mfma_f32_16x16x32_bf16 v[248:251], v[92:95], v[68:71], v[248:251]
  ds_read_b64_tr_b16 v[90:91], v6 offset:4608
  v_mfma_f32_16x16x32_bf16 v[244:247], v[92:95], v[64:67], v[244:247]
  v_mfma_f32_16x16x32_bf16 v[240:243], v[92:95], v[60:63], v[240:243]
  s_waitcnt lgkmcnt(4)
  v_mfma_f32_16x16x32_bf16 v[96:99], v[76:79], v[44:47], v[96:99]
  ds_read_b64_tr_b16 v[92:93], v5 offset:8192
  v_mfma_f32_16x16x32_bf16 v[100:103], v[76:79], v[48:51], v[100:103]
  ds_read_b64_tr_b16 v[94:95], v5 offset:8704
  v_mfma_f32_16x16x32_bf16 v[104:107], v[76:79], v[52:55], v[104:107]
  v_mfma_f32_16x16x32_bf16 v[108:111], v[76:79], v[56:59], v[108:111]
  v_mfma_f32_16x16x32_bf16 v[124:127], v[80:83], v[56:59], v[124:127]
  ds_read_b64_tr_b16 v[76:77], v6 offset:8192
  v_mfma_f32_16x16x32_bf16 v[120:123], v[80:83], v[52:55], v[120:123]
  ds_read_b64_tr_b16 v[78:79], v6 offset:8704
  v_mfma_f32_16x16x32_bf16 v[116:119], v[80:83], v[48:51], v[116:119]
  v_mfma_f32_16x16x32_bf16 v[112:115], v[80:83], v[44:47], v[112:115]
  s_waitcnt lgkmcnt(6)
  v_mfma_f32_16x16x32_bf16 v[128:131], v[84:87], v[44:47], v[128:131]
  ds_read_b64_tr_b16 v[80:81], v5 offset:12288
  v_mfma_f32_16x16x32_bf16 v[132:135], v[84:87], v[48:51], v[132:135]
  ds_read_b64_tr_b16 v[82:83], v5 offset:12800
  v_mfma_f32_16x16x32_bf16 v[136:139], v[84:87], v[52:55], v[136:139]
  v_mfma_f32_16x16x32_bf16 v[140:143], v[84:87], v[56:59], v[140:143]
  s_waitcnt lgkmcnt(6)
  v_mfma_f32_16x16x32_bf16 v[156:159], v[88:91], v[56:59], v[156:159]
  ds_read_b64_tr_b16 v[84:85], v6 offset:12288
  v_mfma_f32_16x16x32_bf16 v[152:155], v[88:91], v[52:55], v[152:155]
  ds_read_b64_tr_b16 v[86:87], v6 offset:12800
  v_mfma_f32_16x16x32_bf16 v[148:151], v[88:91], v[48:51], v[148:151]
  v_mfma_f32_16x16x32_bf16 v[144:147], v[88:91], v[44:47], v[144:147]
  s_waitcnt lgkmcnt(6)
  v_mfma_f32_16x16x32_bf16 v[160:163], v[92:95], v[44:47], v[160:163]
  ds_read_b64_tr_b16 v[88:89], v5 offset:16384
  v_mfma_f32_16x16x32_bf16 v[164:167], v[92:95], v[48:51], v[164:167]
  ds_read_b64_tr_b16 v[90:91], v5 offset:16896
  v_mfma_f32_16x16x32_bf16 v[168:171], v[92:95], v[52:55], v[168:171]
  v_mfma_f32_16x16x32_bf16 v[172:175], v[92:95], v[56:59], v[172:175]
  s_waitcnt lgkmcnt(6)
  v_mfma_f32_16x16x32_bf16 v[188:191], v[76:79], v[56:59], v[188:191]
  ds_read_b64_tr_b16 v[92:93], v6 offset:16384
  v_mfma_f32_16x16x32_bf16 v[184:187], v[76:79], v[52:55], v[184:187]
  ds_read_b64_tr_b16 v[94:95], v6 offset:16896
  v_mfma_f32_16x16x32_bf16 v[180:183], v[76:79], v[48:51], v[180:183]
  v_mfma_f32_16x16x32_bf16 v[176:179], v[76:79], v[44:47], v[176:179]
  s_waitcnt vmcnt(5) lgkmcnt(6)
  s_barrier
  s_add_u32 m0, s22, 16384
  s_nop 0
  buffer_load_dwordx4 v9, s[16:19], s20 offen offset:0 sc1 lds
  buffer_load_dwordx4 v9, s[16:19], s20 offen offset:1024 sc1 lds
  buffer_load_dwordx4 v9, s[16:19], s20 offen offset:2048 sc1 lds
  buffer_load_dwordx4 v9, s[16:19], s20 offen offset:3072 sc1 lds
  s_add_u32 s20, s20, 4096
  v_mfma_f32_16x16x32_bf16 v[192:195], v[80:83], v[44:47], v[192:195]
  ds_read_b64_tr_b16 v[76:77], v5 offset:20480
  v_mfma_f32_16x16x32_bf16 v[196:199], v[80:83], v[48:51], v[196:199]
  ds_read_b64_tr_b16 v[78:79], v5 offset:20992
  v_mfma_f32_16x16x32_bf16 v[200:203], v[80:83], v[52:55], v[200:203]
  ds_read_b128 v[60:63], v2 offset:49152
  v_mfma_f32_16x16x32_bf16 v[204:207], v[80:83], v[56:59], v[204:207]
  ds_read_b128 v[64:67], v2 offset:50176
  s_waitcnt lgkmcnt(8)
  v_mfma_f32_16x16x32_bf16 v[220:223], v[84:87], v[56:59], v[220:223]
  ds_read_b64_tr_b16 v[80:81], v6 offset:20480
  v_mfma_f32_16x16x32_bf16 v[216:219], v[84:87], v[52:55], v[216:219]
  ds_read_b64_tr_b16 v[82:83], v6 offset:20992
  v_mfma_f32_16x16x32_bf16 v[212:215], v[84:87], v[48:51], v[212:215]
  ds_read_b128 v[68:71], v2 offset:51200
  v_mfma_f32_16x16x32_bf16 v[208:211], v[84:87], v[44:47], v[208:211]
  ds_read_b128 v[72:75], v2 offset:52224
  s_waitcnt lgkmcnt(10)
  v_mfma_f32_16x16x32_bf16 v[224:227], v[88:91], v[44:47], v[224:227]
  ds_read_b64_tr_b16 v[84:85], v5 offset:24576
  v_mfma_f32_16x16x32_bf16 v[228:231], v[88:91], v[48:51], v[228:231]
  ds_read_b64_tr_b16 v[86:87], v5 offset:25088
  v_mfma_f32_16x16x32_bf16 v[232:235], v[88:91], v[52:55], v[232:235]
  v_mfma_f32_16x16x32_bf16 v[236:239], v[88:91], v[56:59], v[236:239]
  s_waitcnt lgkmcnt(10)
  v_mfma_f32_16x16x32_bf16 v[252:255], v[92:95], v[56:59], v[252:255]
  ds_read_b64_tr_b16 v[88:89], v6 offset:24576
  v_mfma_f32_16x16x32_bf16 v[248:251], v[92:95], v[52:55], v[248:251]
  ds_read_b64_tr_b16 v[90:91], v6 offset:25088
  v_mfma_f32_16x16x32_bf16 v[244:247], v[92:95], v[48:51], v[244:247]
  v_mfma_f32_16x16x32_bf16 v[240:243], v[92:95], v[44:47], v[240:243]
  s_waitcnt lgkmcnt(4)
  v_mfma_f32_16x16x32_bf16 v[96:99], v[76:79], v[60:63], v[96:99]
  ds_read_b64_tr_b16 v[92:93], v5 offset:28672
  v_mfma_f32_16x16x32_bf16 v[100:103], v[76:79], v[64:67], v[100:103]
  ds_read_b64_tr_b16 v[94:95], v5 offset:29184
  v_mfma_f32_16x16x32_bf16 v[104:107], v[76:79], v[68:71], v[104:107]
  v_mfma_f32_16x16x32_bf16 v[108:111], v[76:79], v[72:75], v[108:111]
  v_mfma_f32_16x16x32_bf16 v[124:127], v[80:83], v[72:75], v[124:127]
  ds_read_b64_tr_b16 v[76:77], v6 offset:28672
  v_mfma_f32_16x16x32_bf16 v[120:123], v[80:83], v[68:71], v[120:123]
  ds_read_b64_tr_b16 v[78:79], v6 offset:29184
  v_mfma_f32_16x16x32_bf16 v[116:119], v[80:83], v[64:67], v[116:119]
  v_mfma_f32_16x16x32_bf16 v[112:115], v[80:83], v[60:63], v[112:115]
  s_waitcnt lgkmcnt(6)
  v_mfma_f32_16x16x32_bf16 v[128:131], v[84:87], v[60:63], v[128:131]
  ds_read_b64_tr_b16 v[80:81], v5 offset:32768
  v_mfma_f32_16x16x32_bf16 v[132:135], v[84:87], v[64:67], v[132:135]
  ds_read_b64_tr_b16 v[82:83], v5 offset:33280
  v_mfma_f32_16x16x32_bf16 v[136:139], v[84:87], v[68:71], v[136:139]
  v_mfma_f32_16x16x32_bf16 v[140:143], v[84:87], v[72:75], v[140:143]
  s_waitcnt lgkmcnt(6)
  v_mfma_f32_16x16x32_bf16 v[156:159], v[88:91], v[72:75], v[156:159]
  ds_read_b64_tr_b16 v[84:85], v6 offset:32768
  v_mfma_f32_16x16x32_bf16 v[152:155], v[88:91], v[68:71], v[152:155]
  ds_read_b64_tr_b16 v[86:87], v6 offset:33280
  v_mfma_f32_16x16x32_bf16 v[148:151], v[88:91], v[64:67], v[148:151]
  v_mfma_f32_16x16x32_bf16 v[144:147], v[88:91], v[60:63], v[144:147]
  s_waitcnt lgkmcnt(6)
  v_mfma_f32_16x16x32_bf16 v[160:163], v[92:95], v[60:63], v[160:163]
  ds_read_b64_tr_b16 v[88:89], v5 offset:36864
  v_mfma_f32_16x16x32_bf16 v[164:167], v[92:95], v[64:67], v[164:167]
  ds_read_b64_tr_b16 v[90:91], v5 offset:37376
  v_mfma_f32_16x16x32_bf16 v[168:171], v[92:95], v[68:71], v[168:171]
  v_mfma_f32_16x16x32_bf16 v[172:175], v[92:95], v[72:75], v[172:175]
  s_waitcnt lgkmcnt(6)
  v_mfma_f32_16x16x32_bf16 v[188:191], v[76:79], v[72:75], v[188:191]
  ds_read_b64_tr_b16 v[92:93], v6 offset:36864
  v_mfma_f32_16x16x32_bf16 v[184:187], v[76:79], v[68:71], v[184:187]
  ds_read_b64_tr_b16 v[94:95], v6 offset:37376
  v_mfma_f32_16x16x32_bf16 v[180:183], v[76:79], v[64:67], v[180:183]
  v_mfma_f32_16x16x32_bf16 v[176:179], v[76:79], v[60:63], v[176:179]
  s_waitcnt vmcnt(4) lgkmcnt(6)
  s_barrier
  s_add_u32 m0, s22, 32768
  s_nop 0
  buffer_load_dwordx4 v9, s[16:19], s20 offen offset:0 sc1 lds
  buffer_load_dwordx4 v9, s[16:19], s20 offen offset:1024 sc1 lds
  buffer_load_dwordx4 v9, s[16:19], s20 offen offset:2048 sc1 lds
  buffer_load_dwordx4 v9, s[16:19], s20 offen offset:3072 sc1 lds
  s_add_u32 s20, s20, 4096
  s_and_b32 s31, s35, 0x60
  v_xor_b32 v15, s31, v14
  s_add_u32 s35, s35, 32
  s_cmp_ge_u32 s24, 2
  s_cselect_b32 s31, s62, 0x7f000000
  buffer_store_dwordx4 v[16:19], v15, s[56:59], s31 offen sc1
  s_add_u32 s62, s62, 256
  v_mfma_f32_16x16x32_bf16 v[192:195], v[80:83], v[60:63], v[192:195]
  ds_read_b64_tr_b16 v[76:77], v3 offset:0
  v_mfma_f32_16x16x32_bf16 v[196:199], v[80:83], v[64:67], v[196:199]
  ds_read_b64_tr_b16 v[78:79], v3 offset:512
  v_mfma_f32_16x16x32_bf16 v[200:203], v[80:83], v[68:71], v[200:203]
  ds_read_b128 v[44:47], v2 offset:0
  v_mfma_f32_16x16x32_bf16 v[204:207], v[80:83], v[72:75], v[204:207]
  ds_read_b128 v[48:51], v2 offset:1024
  s_waitcnt lgkmcnt(8)
  v_mfma_f32_16x16x32_bf16 v[220:223], v[84:87], v[72:75], v[220:223]
  ds_read_b64_tr_b16 v[80:81], v4 offset:0
  v_mfma_f32_16x16x32_bf16 v[216:219], v[84:87], v[68:71], v[216:219]
  ds_read_b64_tr_b16 v[82:83], v4 offset:512
  v_mfma_f32_16x16x32_bf16 v[212:215], v[84:87], v[64:67], v[212:215]
  ds_read_b128 v[52:55], v2 offset:2048
  v_mfma_f32_16x16x32_bf16 v[208:211], v[84:87], v[60:63], v[208:211]
  ds_read_b128 v[56:59], v2 offset:3072
  s_waitcnt lgkmcnt(10)
  v_mfma_f32_16x16x32_bf16 v[224:227], v[88:91], v[60:63], v[224:227]
  ds_read_b64_tr_b16 v[84:85], v3 offset:4096
  v_mfma_f32_16x16x32_bf16 v[228:231], v[88:91], v[64:67], v[228:231]
  ds_read_b64_tr_b16 v[86:87], v3 offset:4608
  v_mfma_f32_16x16x32_bf16 v[232:235], v[88:91], v[68:71], v[232:235]
  v_mfma_f32_16x16x32_bf16 v[236:239], v[88:91], v[72:75], v[236:239]
  s_waitcnt lgkmcnt(10)
  v_mfma_f32_16x16x32_bf16 v[252:255], v[92:95], v[72:75], v[252:255]
  ds_read_b64_tr_b16 v[88:89], v4 offset:4096
  v_mfma_f32_16x16x32_bf16 v[248:251], v[92:95], v[68:71], v[248:251]
  ds_read_b64_tr_b16 v[90:91], v4 offset:4608
  v_mfma_f32_16x16x32_bf16 v[244:247], v[92:95], v[64:67], v[244:247]
  v_mfma_f32_16x16x32_bf16 v[240:243], v[92:95], v[60:63], v[240:243]
  s_sub_u32 s24, s24, 1
  s_cmp_lg_u32 s24, 0
  s_cbranch_scc1 k2_loop_Ax
  s_branch mega_epi
mega_xC:
  s_add_u32 m0, s22, 0
  s_nop 0
  buffer_load_dwordx4 v9, s[16:19], s20 offen offset:0 sc1 lds
  buffer_load_dwordx4 v9, s[16:19], s20 offen offset:1024 sc1 lds
  buffer_load_dwordx4 v9, s[16:19], s20 offen offset:2048 sc1 lds
  buffer_load_dwordx4 v9, s[16:19], s20 offen offset:3072 sc1 lds
  s_add_u32 s20, s20, 4096
  s_add_u32 m0, s22, 16384
  s_nop 0
  buffer_load_dwordx4 v9, s[16:19], s20 offen offset:0 sc1 lds
  buffer_load_dwordx4 v9, s[16:19], s20 offen offset:1024 sc1 lds
  buffer_load_dwordx4 v9, s[16:19], s20 offen offset:2048 sc1 lds
  buffer_load_dwordx4 v9, s[16:19], s20 offen offset:3072 sc1 lds
  s_add_u32 s20, s20, 4096
  s_add_u32 m0, s22, 32768
  s_nop 0
  buffer_load_dwordx4 v9, s[16:19], s20 offen offset:0 sc1 lds
  buffer_load_dwordx4 v9, s[16:19], s20 offen offset:1024 sc1 lds
  buffer_load_dwordx4 v9, s[16:19], s20 offen offset:2048 sc1 lds
  buffer_load_dwordx4 v9, s[16:19], s20 offen offset:3072 sc1 lds
  s_add_u32 s20, s20, 4096
  s_mov_b32 s31, 0x7f000000
  buffer_load_dword v1, v9, s[52:55], s31 offen
  s_waitcnt vmcnt(9)
  s_barrier
  ds_read_b64_tr_b16 v[76:77], v3 offset:0
  ds_read_b64_tr_b16 v[78:79], v3 offset:512
  ds_read_b128 v[44:47], v2 offset:0
  ds_read_b128 v[48:51], v2 offset:1024
  ds_read_b64_tr_b16 v[80:81], v4 offset:0
  ds_read_b64_tr_b16 v[82:83], v4 offset:512
  ds_read_b128 v[52:55], v2 offset:2048
  ds_read_b128 v[56:59], v2 offset:3072
  ds_read_b64_tr_b16 v[84:85], v3 offset:4096
  ds_read_b64_tr_b16 v[86:87], v3 offset:4608
  ds_read_b64_tr_b16 v[88:89], v4 offset:4096
  ds_read_b64_tr_b16 v[90:91], v4 offset:4608
  s_mul_i32 s35, s2, 224
  s_mov_b32 s24, 8
.p2align 6
k2_loop_Cx:
  s_waitcnt lgkmcnt(4)
  v_mfma_f32_16x16x32_bf16 v[96:99], v[76:79], v[44:47], v[96:99]
  ds_read_b64_tr_b16 v[92:93], v3 offset:8192
  v_mfma_f32_16x16x32_bf16 v[100:103], v[76:79], v[48:51], v[100:103]
  ds_read_b64_tr_b16 v[94:95], v3 offset:8704
  v_mfma_f32_16x16x32_bf16 v[104:107], v[76:79], v[52:55], v[104:107]
  v_mfma_f32_16x16x32_bf16 v[108:111], v[76:79], v[56:59], v[108:111]
  v_mfma_f32_16x16x32_bf16 v[124:127], v[80:83], v[56:59], v[124:127]
  ds_read_b64_tr_b16 v[76:77], v4 offset:8192
  v_mfma_f32_16x16x32_bf16 v[120:123], v[80:83], v[52:55], v[120:123]
  ds_read_b64_tr_b16 v[78:79], v4 offset:8704
  v_mfma_f32_16x16x32_bf16 v[116:119], v[80:83], v[48:51], v[116:119]
  v_mfma_f32_16x16x32_bf16 v[112:115], v[80:83], v[44:47], v[112:115]
  s_waitcnt lgkmcnt(6)
  v_mfma_f32_16x16x32_bf16 v[128:131], v[44:47], v[84:87], v[128:131]
  ds_read_b64_tr_b16 v[80:81], v3 offset:12288
  v_mfma_f32_16x16x32_bf16 v[132:135], v[48:51], v[84:87], v[132:135]
  ds_read_b64_tr_b16 v[82:83], v3 offset:12800
  v_mfma_f32_16x16x32_bf16 v[136:139], v[52:55], v[84:87], v[136:139]
  v_mfma_f32_16x16x32_bf16 v[140:143], v[56:59], v[84:87], v[140:143]
  s_waitcnt lgkmcnt(6)
  v_mfma_f32_16x16x32_bf16 v[156:159], v[56:59], v[88:91], v[156:159]
  ds_read_b64_tr_b16 v[84:85], v4 offset:12288
  v_mfma_f32_16x16x32_bf16 v[152:155], v[52:55], v[88:91], v[152:155]
  ds_read_b64_tr_b16 v[86:87], v4 offset:12800
  v_mfma_f32_16x16x32_bf16 v[148:151], v[48:51], v[88:91], v[148:151]
  v_mfma_f32_16x16x32_bf16 v[144:147], v[44:47], v[88:91], v[144:147]
  s_waitcnt lgkmcnt(6)
  v_mfma_f32_16x16x32_bf16 v[160:163], v[92:95], v[44:47], v[160:163]
  ds_read_b64_tr_b16 v[88:89], v3 offset:16384
  v_mfma_f32_16x16x32_bf16 v[164:167], v[92:95], v[48:51], v[164:167]
  ds_read_b64_tr_b16 v[90:91], v3 offset:16896
  v_mfma_f32_16x16x32_bf16 v[168:171], v[92:95], v[52:55], v[168:171]
  v_mfma_f32_16x16x32_bf16 v[172:175], v[92:95], v[56:59], v[172:175]
  s_waitcnt lgkmcnt(6)
  v_mfma_f32_16x16x32_bf16 v[188:191], v[76:79], v[56:59], v[188:191]
  ds_read_b64_tr_b16 v[92:93], v4 offset:16384
  v_mfma_f32_16x16x32_bf16 v[184:187], v[76:79], v[52:55], v[184:187]
  ds_read_b64_tr_b16 v[94:95], v4 offset:16896
  v_mfma_f32_16x16x32_bf16 v[180:183], v[76:79], v[48:51], v[180:183]
  v_mfma_f32_16x16x32_bf16 v[176:179], v[76:79], v[44:47], v[176:179]
  s_waitcnt vmcnt(5) lgkmcnt(6)
  s_barrier
  s_add_u32 m0, s22, 49152
  s_nop 0
  buffer_load_dwordx4 v9, s[16:19], s20 offen offset:0 sc1 lds
  buffer_load_dwordx4 v9, s[16:19], s20 offen offset:1024 sc1 lds
  buffer_load_dwordx4 v9, s[16:19], s20 offen offset:2048 sc1 lds
  buffer_load_dwordx4 v9, s[16:19], s20 offen offset:3072 sc1 lds
  s_add_u32 s20, s20, 4096
  s_cmp_eq_u32 s24, 1
  s_cselect_b32 s20, 0x7f000000, s20
  buffer_load_dwordx4 v[16:19], v9, s[52:55], s50 offen nt
  s_add_u32 s50, s50, 4096
  v_mfma_f32_16x16x32_bf16 v[192:195], v[44:47], v[80:83], v[192:195]
  ds_read_b64_tr_b16 v[76:77], v3 offset:20480
  v_mfma_f32_16x16x32_bf16 v[196:199], v[48:51], v[80:83], v[196:199]
  ds_read_b64_tr_b16 v[78:79], v3 offset:20992
  v_mfma_f32_16x16x32_bf16 v[200:203], v[52:55], v[80:83], v[200:203]
  ds_read_b128 v[60:63], v2 offset:16384
  v_mfma_f32_16x16x32_bf16 v[204:207], v[56:59], v[80:83], v[204:207]
  ds_read_b128 v[64:67], v2 offset:17408
  s_waitcnt lgkmcnt(8)
  v_mfma_f32_16x16x32_bf16 v[220:223], v[56:59], v[84:87], v[220:223]
  ds_read_b64_tr_b16 v[80:81], v4 offset:20480
  v_mfma_f32_16x16x32_bf16 v[216:219], v[52:55], v[84:87], v[216:219]
  ds_read_b64_tr_b16 v[82:83], v4 offset:20992
  v_mfma_f32_16x16x32_bf16 v[212:215], v[48:51], v[84:87], v[212:215]
  ds_read_b128 v[68:71], v2 offset:18432
  v_mfma_f32_16x16x32_bf16 v[208:211], v[44:47], v[84:87], v[208:211]
  ds_read_b128 v[72:75], v2 offset:19456
  s_waitcnt lgkmcnt(10)
  v_mfma_f32_16x16x32_bf16 v[224:227], v[88:91], v[44:47], v[224:227]
  ds_read_b64_tr_b16 v[84:85], v3 offset:24576
  v_mfma_f32_16x16x32_bf16 v[228:231], v[88:91], v[48:51], v[228:231]
  ds_read_b64_tr_b16 v[86:87], v3 offset:25088
  v_mfma_f32_16x16x32_bf16 v[232:235], v[88:91], v[52:55], v[232:235]
  v_mfma_f32_16x16x32_bf16 v[236:239], v[88:91], v[56:59], v[236:239]
  s_waitcnt lgkmcnt(10)
  v_mfma_f32_16x16x32_bf16 v[252:255], v[92:95], v[56:59], v[252:255]
  ds_read_b64_tr_b16 v[88:89], v4 offset:24576
  v_mfma_f32_16x16x32_bf16 v[248:251], v[92:95], v[52:55], v[248:251]
  ds_read_b64_tr_b16 v[90:91], v4 offset:25088
  v_mfma_f32_16x16x32_bf16 v[244:247], v[92:95], v[48:51], v[244:247]
  v_mfma_f32_16x16x32_bf16 v[240:243], v[92:95], v[44:47], v[240:243]
  s_waitcnt lgkmcnt(4)
  v_mfma_f32_16x16x32_bf16 v[96:99], v[76:79], v[60:63], v[96:99]
  ds_read_b64_tr_b16 v[92:93], v3 offset:28672
  v_mfma_f32_16x16x32_bf16 v[100:103], v[76:79], v[64:67], v[100:103]
  ds_read_b64_tr_b16 v[94:95], v3 offset:29184
  v_mfma_f32_16x16x32_bf16 v[104:107], v[76:79], v[68:71], v[104:107]
  v_mfma_f32_16x16x32_bf16 v[108:111], v[76:79], v[72:75], v[108:111]
  v_mfma_f32_16x16x32_bf16 v[124:127], v[80:83], v[72:75], v[124:127]
  ds_read_b64_tr_b16 v[76:77], v4 offset:28672
  v_mfma_f32_16x16x32_bf16 v[120:123], v[80:83], v[68:71], v[120:123]
  ds_read_b64_tr_b16 v[78:79], v4 offset:29184
  v_mfma_f32_16x16x32_bf16 v[116:119], v[80:83], v[64:67], v[116:119]
  v_mfma_f32_16x16x32_bf16 v[112:115], v[80:83], v[60:63], v[112:115]
  s_waitcnt lgkmcnt(6)
  v_mfma_f32_16x16x32_bf16 v[128:131], v[60:63], v[84:87], v[128:131]
  ds_read_b64_tr_b16 v[80:81], v3 offset:32768
  v_mfma_f32_16x16x32_bf16 v[132:135], v[64:67], v[84:87], v[132:135]
  ds_read_b64_tr_b16 v[82:83], v3 offset:33280
  v_mfma_f32_16x16x32_bf16 v[136:139], v[68:71], v[84:87], v[136:139]
  v_mfma_f32_16x16x32_bf16 v[140:143], v[72:75], v[84:87], v[140:143]
  s_waitcnt lgkmcnt(6)
  v_mfma_f32_16x16x32_bf16 v[156:159], v[72:75], v[88:91], v[156:159]
  ds_read_b64_tr_b16 v[84:85], v4 offset:32768
  v_mfma_f32_16x16x32_bf16 v[152:155], v[68:71], v[88:91], v[152:155]
  ds_read_b64_tr_b16 v[86:87], v4 offset:33280
  v_mfma_f32_16x16x32_bf16 v[148:151], v[64:67], v[88:91], v[148:151]
  v_mfma_f32_16x16x32_bf16 v[144:147], v[60:63], v[88:91], v[144:147]
  s_waitcnt lgkmcnt(6)
  v_mfma_f32_16x16x32_bf16 v[160:163], v[92:95], v[60:63], v[160:163]
  ds_read_b64_tr_b16 v[88:89], v3 offset:36864
  v_mfma_f32_16x16x32_bf16 v[164:167], v[92:95], v[64:67], v[164:167]
  ds_read_b64_tr_b16 v[90:91], v3 offset:37376
  v_mfma_f32_16x16x32_bf16 v[168:171], v[92:95], v[68:71], v[168:171]
  v_mfma_f32_16x16x32_bf16 v[172:175], v[92:95], v[72:75], v[172:175]
  s_waitcnt lgkmcnt(6)
  v_mfma_f32_16x16x32_bf16 v[188:191], v[76:79], v[72:75], v[188:191]
  ds_read_b64_tr_b16 v[92:93], v4 offset:36864
  v_mfma_f32_16x16x32_bf16 v[184:187], v[76:79], v[68:71], v[184:187]
  ds_read_b64_tr_b16 v[94:95], v4 offset:37376
  v_mfma_f32_16x16x32_bf16 v[180:183], v[76:79], v[64:67], v[180:183]
  v_mfma_f32_16x16x32_bf16 v[176:179], v[76:79], v[60:63], v[176:179]
  s_waitcnt vmcnt(6) lgkmcnt(6)
  s_barrier
  s_add_u32 m0, s22, 0
  s_nop 0
  buffer_load_dwordx4 v9, s[16:19], s20 offen offset:0 sc1 lds
  buffer_load_dwordx4 v9, s[16:19], s20 offen offset:1024 sc1 lds
  buffer_load_dwordx4 v9, s[16:19], s20 offen offset:2048 sc1 lds
  buffer_load_dwordx4 v9, s[16:19], s20 offen offset:3072 sc1 lds
  s_add_u32 s20, s20, 4096
  v_mfma_f32_16x16x32_bf16 v[192:195], v[60:63], v[80:83], v[192:195]
  ds_read_b64_tr_b16 v[76:77], v5 offset:0
  v_mfma_f32_16x16x32_bf16 v[196:199], v[64:67], v[80:83], v[196:199]
  ds_read_b64_tr_b16 v[78:79], v5 offset:512
  v_mfma_f32_16x16x32_bf16 v[200:203], v[68:71], v[80:83], v[200:203]
  ds_read_b128 v[44:47], v2 offset:32768
  v_mfma_f32_16x16x32_bf16 v[204:207], v[72:75], v[80:83], v[204:207]
  ds_read_b128 v[48:51], v2 offset:33792
  s_waitcnt lgkmcnt(8)
  v_mfma_f32_16x16x32_bf16 v[220:223], v[72:75], v[84:87], v[220:223]
  ds_read_b64_tr_b16 v[80:81], v6 offset:0
  v_mfma_f32_16x16x32_bf16 v[216:219], v[68:71], v[84:87], v[216:219]
  ds_read_b64_tr_b16 v[82:83], v6 offset:512
  v_mfma_f32_16x16x32_bf16 v[212:215], v[64:67], v[84:87], v[212:215]
  ds_read_b128 v[52:55], v2 offset:34816
  v_mfma_f32_16x16x32_bf16 v[208:211], v[60:63], v[84:87], v[208:211]
  ds_read_b128 v[56:59], v2 offset:35840
  s_waitcnt lgkmcnt(10)
  v_mfma_f32_16x16x32_bf16 v[224:227], v[88:91], v[60:63], v[224:227]
  ds_read_b64_tr_b16 v[84:85], v5 offset:4096
  v_mfma_f32_16x16x32_bf16 v[228:231], v[88:91], v[64:67], v[228:231]
  ds_read_b64_tr_b16 v[86:87], v5 offset:4608
  v_mfma_f32_16x16x32_bf16 v[232:235], v[88:91], v[68:71], v[232:235]
  v_mfma_f32_16x16x32_bf16 v[236:239], v[88:91], v[72:75], v[236:239]
  s_waitcnt lgkmcnt(10)
  v_mfma_f32_16x16x32_bf16 v[252:255], v[92:95], v[72:75], v[252:255]
  ds_read_b64_tr_b16 v[88:89], v6 offset:4096
  v_mfma_f32_16x16x32_bf16 v[248:251], v[92:95], v[68:71], v[248:251]
  ds_read_b64_tr_b16 v[90:91], v6 offset:4608
  v_mfma_f32_16x16x32_bf16 v[244:247], v[92:95], v[64:67], v[244:247]
  v_mfma_f32_16x16x32_bf16 v[240:243], v[92:95], v[60:63], v[240:243]
  s_waitcnt lgkmcnt(4)
  v_mfma_f32_16x16x32_bf16 v[96:99], v[76:79], v[44:47], v[96:99]
  ds_read_b64_tr_b16 v[92:93], v5 offset:8192
  v_mfma_f32_16x16x32_bf16 v[100:103], v[76:79], v[48:51], v[100:103]
  ds_read_b64_tr_b16 v[94:95], v5 offset:8704
  v_mfma_f32_16x16x32_bf16 v[104:107], v[76:79], v[52:55], v[104:107]
  v_mfma_f32_16x16x32_bf16 v[108:111], v[76:79], v[56:59], v[108:111]
  v_mfma_f32_16x16x32_bf16 v[124:127], v[80:83], v[56:59], v[124:127]
  ds_read_b64_tr_b16 v[76:77], v6 offset:8192
  v_mfma_f32_16x16x32_bf16 v[120:123], v[80:83], v[52:55], v[120:123]
  ds_read_b64_tr_b16 v[78:79], v6 offset:8704
  v_mfma_f32_16x16x32_bf16 v[116:119], v[80:83], v[48:51], v[116:119]
  v_mfma_f32_16x16x32_bf16 v[112:115], v[80:83], v[44:47], v[112:115]
  s_waitcnt lgkmcnt(6)
  v_mfma_f32_16x16x32_bf16 v[128:131], v[44:47], v[84:87], v[128:131]
  ds_read_b64_tr_b16 v[80:81], v5 offset:12288
  v_mfma_f32_16x16x32_bf16 v[132:135], v[48:51], v[84:87], v[132:135]
  ds_read_b64_tr_b16 v[82:83], v5 offset:12800
  v_mfma_f32_16x16x32_bf16 v[136:139], v[52:55], v[84:87], v[136:139]
  v_mfma_f32_16x16x32_bf16 v[140:143], v[56:59], v[84:87], v[140:143]
  s_waitcnt lgkmcnt(6)
  v_mfma_f32_16x16x32_bf16 v[156:159], v[56:59], v[88:91], v[156:159]
  ds_read_b64_tr_b16 v[84:85], v6 offset:12288
  v_mfma_f32_16x16x32_bf16 v[152:155], v[52:55], v[88:91], v[152:155]
  ds_read_b64_tr_b16 v[86:87], v6 offset:12800
  v_mfma_f32_16x16x32_bf16 v[148:151], v[48:51], v[88:91], v[148:151]
  v_mfma_f32_16x16x32_bf16 v[144:147], v[44:47], v[88:91], v[144:147]
  s_waitcnt lgkmcnt(6)
  v_mfma_f32_16x16x32_bf16 v[160:163], v[92:95], v[44:47], v[160:163]
  ds_read_b64_tr_b16 v[88:89], v5 offset:16384
  v_mfma_f32_16x16x32_bf16 v[164:167], v[92:95], v[48:51], v[164:167]
  ds_read_b64_tr_b16 v[90:91], v5 offset:16896
  v_mfma_f32_16x16x32_bf16 v[168:171], v[92:95], v[52:55], v[168:171]
  v_mfma_f32_16x16x32_bf16 v[172:175], v[92:95], v[56:59], v[172:175]
  s_waitcnt lgkmcnt(6)
  v_mfma_f32_16x16x32_bf16 v[188:191], v[76:79], v[56:59], v[188:191]
  ds_read_b64_tr_b16 v[92:93], v6 offset:16384
  v_mfma_f32_16x16x32_bf16 v[184:187], v[76:79], v[52:55], v[184:187]
  ds_read_b64_tr_b16 v[94:95], v6 offset:16896
  v_mfma_f32_16x16x32_bf16 v[180:183], v[76:79], v[48:51], v[180:183]
  v_mfma_f32_16x16x32_bf16 v[176:179], v[76:79], v[44:47], v[176:179]
  s_waitcnt vmcnt(5) lgkmcnt(6)
  s_barrier
  s_add_u32 m0, s22, 16384
  s_nop 0
  buffer_load_dwordx4 v9, s[16:19], s20 offen offset:0 sc1 lds
  buffer_load_dwordx4 v9, s[16:19], s20 offen offset:1024 sc1 lds
  buffer_load_dwordx4 v9, s[16:19], s20 offen offset:2048 sc1 lds
  buffer_load_dwordx4 v9, s[16:19], s20 offen offset:3072 sc1 lds
  s_add_u32 s20, s20, 4096
  v_mfma_f32_16x16x32_bf16 v[192:195], v[44:47], v[80:83], v[192:195]
  ds_read_b64_tr_b16 v[76:77], v5 offset:20480
  v_mfma_f32_16x16x32_bf16 v[196:199], v[48:51], v[80:83], v[196:199]
  ds_read_b64_tr_b16 v[78:79], v5 offset:20992
  v_mfma_f32_16x16x32_bf16 v[200:203], v[52:55], v[80:83], v[200:203]
  ds_read_b128 v[60:63], v2 offset:49152
  v_mfma_f32_16x16x32_bf16 v[204:207], v[56:59], v[80:83], v[204:207]
  ds_read_b128 v[64:67], v2 offset:50176
  s_waitcnt lgkmcnt(8)
  v_mfma_f32_16x16x32_bf16 v[220:223], v[56:59], v[84:87], v[220:223]
  ds_read_b64_tr_b16 v[80:81], v6 offset:20480
  v_mfma_f32_16x16x32_bf16 v[216:219], v[52:55], v[84:87], v[216:219]
  ds_read_b64_tr_b16 v[82:83], v6 offset:20992
  v_mfma_f32_16x16x32_bf16 v[212:215], v[48:51], v[84:87], v[212:215]
  ds_read_b128 v[68:71], v2 offset:51200
  v_mfma_f32_16x16x32_bf16 v[208:211], v[44:47], v[84:87], v[208:211]
  ds_read_b128 v[72:75], v2 offset:52224
  s_waitcnt lgkmcnt(10)
  v_mfma_f32_16x16x32_bf16 v[224:227], v[88:91], v[44:47], v[224:227]
  ds_read_b64_tr_b16 v[84:85], v5 offset:24576
  v_mfma_f32_16x16x32_bf16 v[228:231], v[88:91], v[48:51], v[228:231]
  ds_read_b64_tr_b16 v[86:87], v5 offset:25088
  v_mfma_f32_16x16x32_bf16 v[232:235], v[88:91], v[52:55], v[232:235]
  v_mfma_f32_16x16x32_bf16 v[236:239], v[88:91], v[56:59], v[236:239]
  s_waitcnt lgkmcnt(10)
  v_mfma_f32_16x16x32_bf16 v[252:255], v[92:95], v[56:59], v[252:255]
  ds_read_b64_tr_b16 v[88:89], v6 offset:24576
  v_mfma_f32_16x16x32_bf16 v[248:251], v[92:95], v[52:55], v[248:251]
  ds_read_b64_tr_b16 v[90:91], v6 offset:25088
  v_mfma_f32_16x16x32_bf16 v[244:247], v[92:95], v[48:51], v[244:247]
  v_mfma_f32_16x16x32_bf16 v[240:243], v[92:95], v[44:47], v[240:243]
  s_waitcnt lgkmcnt(4)
  v_mfma_f32_16x16x32_bf16 v[96:99], v[76:79], v[60:63], v[96:99]
  ds_read_b64_tr_b16 v[92:93], v5 offset:28672
  v_mfma_f32_16x16x32_bf16 v[100:103], v[76:79], v[64:67], v[100:103]
  ds_read_b64_tr_b16 v[94:95], v5 offset:29184
  v_mfma_f32_16x16x32_bf16 v[104:107], v[76:79], v[68:71], v[104:107]
  v_mfma_f32_16x16x32_bf16 v[108:111], v[76:79], v[72:75], v[108:111]
  v_mfma_f32_16x16x32_bf16 v[124:127], v[80:83], v[72:75], v[124:127]
  ds_read_b64_tr_b16 v[76:77], v6 offset:28672
  v_mfma_f32_16x16x32_bf16 v[120:123], v[80:83], v[68:71], v[120:123]
  ds_read_b64_tr_b16 v[78:79], v6 offset:29184
  v_mfma_f32_16x16x32_bf16 v[116:119], v[80:83], v[64:67], v[116:119]
  v_mfma_f32_16x16x32_bf16 v[112:115], v[80:83], v[60:63], v[112:115]
  s_waitcnt lgkmcnt(6)
  v_mfma_f32_16x16x32_bf16 v[128:131], v[60:63], v[84:87], v[128:131]
  ds_read_b64_tr_b16 v[80:81], v5 offset:32768
  v_mfma_f32_16x16x32_bf16 v[132:135], v[64:67], v[84:87], v[132:135]
  ds_read_b64_tr_b16 v[82:83], v5 offset:33280
  v_mfma_f32_16x16x32_bf16 v[136:139], v[68:71], v[84:87], v[136:139]
  v_mfma_f32_16x16x32_bf16 v[140:143], v[72:75], v[84:87], v[140:143]
  s_waitcnt lgkmcnt(6)
  v_mfma_f32_16x16x32_bf16 v[156:159], v[72:75], v[88:91], v[156:159]
  ds_read_b64_tr_b16 v[84:85], v6 offset:32768
  v_mfma_f32_16x16x32_bf16 v[152:155], v[68:71], v[88:91], v[152:155]
  ds_read_b64_tr_b16 v[86:87], v6 offset:33280
  v_mfma_f32_16x16x32_bf16 v[148:151], v[64:67], v[88:91], v[148:151]
  v_mfma_f32_16x16x32_bf16 v[144:147], v[60:63], v[88:91], v[144:147]
  s_waitcnt lgkmcnt(6)
  v_mfma_f32_16x16x32_bf16 v[160:163], v[92:95], v[60:63], v[160:163]
  ds_read_b64_tr_b16 v[88:89], v5 offset:36864
  v_mfma_f32_16x16x32_bf16 v[164:167], v[92:95], v[64:67], v[164:167]
  ds_read_b64_tr_b16 v[90:91], v5 offset:37376
  v_mfma_f32_16x16x32_bf16 v[168:171], v[92:95], v[68:71], v[168:171]
  v_mfma_f32_16x16x32_bf16 v[172:175], v[92:95], v[72:75], v[172:175]
  s_waitcnt lgkmcnt(6)
  v_mfma_f32_16x16x32_bf16 v[188:191], v[76:79], v[72:75], v[188:191]
  ds_read_b64_tr_b16 v[92:93], v6 offset:36864
  v_mfma_f32_16x16x32_bf16 v[184:187], v[76:79], v[68:71], v[184:187]
  ds_read_b64_tr_b16 v[94:95], v6 offset:37376
  v_mfma_f32_16x16x32_bf16 v[180:183], v[76:79], v[64:67], v[180:183]
  v_mfma_f32_16x16x32_bf16 v[176:179], v[76:79], v[60:63], v[176:179]
  s_waitcnt vmcnt(4) lgkmcnt(6)
  s_barrier
  s_add_u32 m0, s22, 32768
  s_nop 0
  buffer_load_dwordx4 v9, s[16:19], s20 offen offset:0 sc1 lds
  buffer_load_dwordx4 v9, s[16:19], s20 offen offset:1024 sc1 lds
  buffer_load_dwordx4 v9, s[16:19], s20 offen offset:2048 sc1 lds
  buffer_load_dwordx4 v9, s[16:19], s20 offen offset:3072 sc1 lds
  s_add_u32 s20, s20, 4096
  s_and_b32 s31, s35, 0x60
  v_xor_b32 v15, s31, v14
  s_add_u32 s35, s35, 32
  s_cmp_ge_u32 s24, 2
  s_cselect_b32 s31, s62, 0x7f000000
  buffer_store_dwordx4 v[16:19], v15, s[56:59], s31 offen sc1
  s_add_u32 s62, s62, 256
  v_mfma_f32_16x16x32_bf16 v[192:195], v[60:63], v[80:83], v[192:195]
  ds_read_b64_tr_b16 v[76:77], v3 offset:0
  v_mfma_f32_16x16x32_bf16 v[196:199], v[64:67], v[80:83], v[196:199]
  ds_read_b64_tr_b16 v[78:79], v3 offset:512
  v_mfma_f32_16x16x32_bf16 v[200:203], v[68:71], v[80:83], v[200:203]
  ds_read_b128 v[44:47], v2 offset:0
  v_mfma_f32_16x16x32_bf16 v[204:207], v[72:75], v[80:83], v[204:207]
  ds_read_b128 v[48:51], v2 offset:1024
  s_waitcnt lgkmcnt(8)
  v_mfma_f32_16x16x32_bf16 v[220:223], v[72:75], v[84:87], v[220:223]
  ds_read_b64_tr_b16 v[80:81], v4 offset:0
  v_mfma_f32_16x16x32_bf16 v[216:219], v[68:71], v[84:87], v[216:219]
  ds_read_b64_tr_b16 v[82:83], v4 offset:512
  v_mfma_f32_16x16x32_bf16 v[212:215], v[64:67], v[84:87], v[212:215]
  ds_read_b128 v[52:55], v2 offset:2048
  v_mfma_f32_16x16x32_bf16 v[208:211], v[60:63], v[84:87], v[208:211]
  ds_read_b128 v[56:59], v2 offset:3072
  s_waitcnt lgkmcnt(10)
  v_mfma_f32_16x16x32_bf16 v[224:227], v[88:91], v[60:63], v[224:227]
  ds_read_b64_tr_b16 v[84:85], v3 offset:4096
  v_mfma_f32_16x16x32_bf16 v[228:231], v[88:91], v[64:67], v[228:231]
  ds_read_b64_tr_b16 v[86:87], v3 offset:4608
  v_mfma_f32_16x16x32_bf16 v[232:235], v[88:91], v[68:71], v[232:235]
  v_mfma_f32_16x16x32_bf16 v[236:239], v[88:91], v[72:75], v[236:239]
  s_waitcnt lgkmcnt(10)
  v_mfma_f32_16x16x32_bf16 v[252:255], v[92:95], v[72:75], v[252:255]
  ds_read_b64_tr_b16 v[88:89], v4 offset:4096
  v_mfma_f32_16x16x32_bf16 v[248:251], v[92:95], v[68:71], v[248:251]
  ds_read_b64_tr_b16 v[90:91], v4 offset:4608
  v_mfma_f32_16x16x32_bf16 v[244:247], v[92:95], v[64:67], v[244:247]
  v_mfma_f32_16x16x32_bf16 v[240:243], v[92:95], v[60:63], v[240:243]
  s_sub_u32 s24, s24, 1
  s_cmp_lg_u32 s24, 0
  s_cbranch_scc1 k2_loop_Cx
  s_branch mega_epi
mega_w:
  s_cmp_eq_u32 s27, 3
  s_cbranch_scc1 mega_wC
  s_waitcnt vmcnt(5)
  s_barrier
  ds_read_b64_tr_b16 v[76:77], v3 offset:0
  ds_read_b64_tr_b16 v[78:79], v3 offset:512
  ds_read_b128 v[44:47], v2 offset:0
  ds_read_b128 v[48:51], v2 offset:1024
  ds_read_b64_tr_b16 v[80:81], v4 offset:0
  ds_read_b64_tr_b16 v[82:83], v4 offset:512
  ds_read_b128 v[52:55], v2 offset:2048
  ds_read_b128 v[56:59], v2 offset:3072
  ds_read_b64_tr_b16 v[84:85], v3 offset:4096
  ds_read_b64_tr_b16 v[86:87], v3 offset:4608
  ds_read_b64_tr_b16 v[88:89], v4 offset:4096
  ds_read_b64_tr_b16 v[90:91], v4 offset:4608
  s_mov_b32 s35, 64
  s_mov_b32 s24, 8
.p2align 6
k2_loop_Aw:
  s_waitcnt lgkmcnt(4)
  v_mfma_f32_16x16x32_bf16 v[96:99], v[76:79], v[44:47], v[96:99]
  ds_read_b64_tr_b16 v[92:93], v3 offset:8192
  v_mfma_f32_16x16x32_bf16 v[100:103], v[76:79], v[48:51], v[100:103]
  ds_read_b64_tr_b16 v[94:95], v3 offset:8704
  v_mfma_f32_16x16x32_bf16 v[104:107], v[76:79], v[52:55], v[104:107]
  s_add_u32 m0, s22, 106496
  s_nop 0
  buffer_load_dwordx4 v7, s[4:7], s20 offen offset:0 nt lds
  v_mfma_f32_16x16x32_bf16 v[108:111], v[76:79], v[56:59], v[108:111]
  v_mfma_f32_16x16x32_bf16 v[124:127], v[80:83], v[56:59], v[124:127]
  ds_read_b64_tr_b16 v[76:77], v4 offset:8192
  v_mfma_f32_16x16x32_bf16 v[120:123], v[80:83], v[52:55], v[120:123]
  ds_read_b64_tr_b16 v[78:79], v4 offset:8704
  v_mfma_f32_16x16x32_bf16 v[116:119], v[80:83], v[48:51], v[116:119]
  s_add_u32 m0, s22, 110464
  s_nop 0
  buffer_load_dwordx4 v7, s[4:7], s20 offen offset:128 nt lds
  v_mfma_f32_16x16x32_bf16 v[112:115], v[80:83], v[44:47], v[112:115]
  s_waitcnt lgkmcnt(6)
  v_mfma_f32_16x16x32_bf16 v[128:131], v[84:87], v[44:47], v[128:131]
  ds_read_b64_tr_b16 v[80:81], v3 offset:12288
  v_mfma_f32_16x16x32_bf16 v[132:135], v[84:87], v[48:51], v[132:135]
  ds_read_b64_tr_b16 v[82:83], v3 offset:12800
  v_mfma_f32_16x16x32_bf16 v[136:139], v[84:87], v[52:55], v[136:139]
  s_add_u32 m0, s22, 114688
  s_nop 0
  buffer_load_dwordx4 v7, s[8:11], s20 offen offset:0 nt lds
  v_mfma_f32_16x16x32_bf16 v[140:143], v[84:87], v[56:59], v[140:143]
  s_waitcnt lgkmcnt(6)
  v_mfma_f32_16x16x32_bf16 v[156:159], v[88:91], v[56:59], v[156:159]
  ds_read_b64_tr_b16 v[84:85], v4 offset:12288
  v_mfma_f32_16x16x32_bf16 v[152:155], v[88:91], v[52:55], v[152:155]
  ds_read_b64_tr_b16 v[86:87], v4 offset:12800
  v_mfma_f32_16x16x32_bf16 v[148:151], v[88:91], v[48:51], v[148:151]
  s_add_u32 m0, s22, 118656
  s_nop 0
  buffer_load_dwordx4 v7, s[8:11], s20 offen offset:128 nt lds
  v_mfma_f32_16x16x32_bf16 v[144:147], v[88:91], v[44:47], v[144:147]
  s_waitcnt lgkmcnt(6)
  v_mfma_f32_16x16x32_bf16 v[160:163], v[92:95], v[44:47], v[160:163]
  ds_read_b64_tr_b16 v[88:89], v3 offset:16384
  v_mfma_f32_16x16x32_bf16 v[164:167], v[92:95], v[48:51], v[164:167]
  ds_read_b64_tr_b16 v[90:91], v3 offset:16896
  v_mfma_f32_16x16x32_bf16 v[168:171], v[92:95], v[52:55], v[168:171]
  s_add_u32 m0, s22, 122880
  s_nop 0
  buffer_load_dwordx4 v8, s[12:15], s21 offen offset:0 nt lds
  s_add_u32 s20, s20, 229376
  s_add_u32 s21, s21, 196608
  s_and_b32 s31, s35, 0x40
  v_xor_b32 v15, s31, v14
  s_add_u32 s35, s35, 64
  s_bitcmp1_b32 0xc0, s24
  s_cselect_b32 s31, s62, 0x7f000000
  buffer_store_dwordx4 v[16:19], v15, s[56:59], s31 offen sc1
  s_add_u32 s62, s62, 256
  v_mfma_f32_16x16x32_bf16 v[172:175], v[92:95], v[56:59], v[172:175]
  s_waitcnt lgkmcnt(6)
  v_mfma_f32_16x16x32_bf16 v[188:191], v[76:79], v[56:59], v[188:191]
  ds_read_b64_tr_b16 v[92:93], v4 offset:16384
  v_mfma_f32_16x16x32_bf16 v[184:187], v[76:79], v[52:55], v[184:187]
  ds_read_b64_tr_b16 v[94:95], v4 offset:16896
  v_mfma_f32_16x16x32_bf16 v[180:183], v[76:79], v[48:51], v[180:183]
  v_mfma_f32_16x16x32_bf16 v[176:179], v[76:79], v[44:47], v[176:179]
  s_waitcnt vmcnt(6) lgkmcnt(6)
  s_barrier
  v_mfma_f32_16x16x32_bf16 v[192:195], v[80:83], v[44:47], v[192:195]
  ds_read_b64_tr_b16 v[76:77], v3 offset:20480
  v_mfma_f32_16x16x32_bf16 v[196:199], v[80:83], v[48:51], v[196:199]
  ds_read_b64_tr_b16 v[78:79], v3 offset:20992
  v_mfma_f32_16x16x32_bf16 v[200:203], v[80:83], v[52:55], v[200:203]
  ds_read_b128 v[60:63], v2 offset:16384
  v_mfma_f32_16x16x32_bf16 v[204:207], v[80:83], v[56:59], v[204:207]
  ds_read_b128 v[64:67], v2 offset:17408
  s_waitcnt lgkmcnt(8)
  v_mfma_f32_16x16x32_bf16 v[220:223], v[84:87], v[56:59], v[220:223]
  ds_read_b64_tr_b16 v[80:81], v4 offset:20480
  v_mfma_f32_16x16x32_bf16 v[216:219], v[84:87], v[52:55], v[216:219]
  ds_read_b64_tr_b16 v[82:83], v4 offset:20992
  v_mfma_f32_16x16x32_bf16 v[212:215], v[84:87], v[48:51], v[212:215]
  ds_read_b128 v[68:71], v2 offset:18432
  v_mfma_f32_16x16x32_bf16 v[208:211], v[84:87], v[44:47], v[208:211]
  ds_read_b128 v[72:75], v2 offset:19456
  s_waitcnt lgkmcnt(10)
  v_mfma_f32_16x16x32_bf16 v[224:227], v[88:91], v[44:47], v[224:227]
  ds_read_b64_tr_b16 v[84:85], v3 offset:24576
  v_mfma_f32_16x16x32_bf16 v[228:231], v[88:91], v[48:51], v[228:231]
  ds_read_b64_tr_b16 v[86:87], v3 offset:25088
  v_mfma_f32_16x16x32_bf16 v[232:235], v[88:91], v[52:55], v[232:235]
  v_mfma_f32_16x16x32_bf16 v[236:239], v[88:91], v[56:59], v[236:239]
  s_waitcnt lgkmcnt(10)
  v_mfma_f32_16x16x32_bf16 v[252:255], v[92:95], v[56:59], v[252:255]
  ds_read_b64_tr_b16 v[88:89], v4 offset:24576
  v_mfma_f32_16x16x32_bf16 v[248:251], v[92:95], v[52:55], v[248:251]
  ds_read_b64_tr_b16 v[90:91], v4 offset:25088
  v_mfma_f32_16x16x32_bf16 v[244:247], v[92:95], v[48:51], v[244:247]
  v_mfma_f32_16x16x32_bf16 v[240:243], v[92:95], v[44:47], v[240:243]
  s_waitcnt lgkmcnt(4)
  v_mfma_f32_16x16x32_bf16 v[96:99], v[76:79], v[60:63], v[96:99]
  ds_read_b64_tr_b16 v[92:93], v3 offset:28672
  v_mfma_f32_16x16x32_bf16 v[100:103], v[76:79], v[64:67], v[100:103]
  ds_read_b64_tr_b16 v[94:95], v3 offset:29184
  v_mfma_f32_16x16x32_bf16 v[104:107], v[76:79], v[68:71], v[104:107]
  s_add_u32 m0, s22, 126976
  s_nop 0
  buffer_load_dwordx4 v7, s[4:7], s20 offen offset:0 nt lds
  v_mfma_f32_16x16x32_bf16 v[108:111], v[76:79], v[72:75], v[108:111]
  v_mfma_f32_16x16x32_bf16 v[124:127], v[80:83], v[72:75], v[124:127]
  ds_read_b64_tr_b16 v[76:77], v4 offset:28672
  v_mfma_f32_16x16x32_bf16 v[120:123], v[80:83], v[68:71], v[120:123]
  ds_read_b64_tr_b16 v[78:79], v4 offset:29184
  v_mfma_f32_16x16x32_bf16 v[116:119], v[80:83], v[64:67], v[116:119]
  s_add_u32 m0, s22, 130944
  s_nop 0
  buffer_load_dwordx4 v7, s[4:7], s20 offen offset:128 nt lds
  v_mfma_f32_16x16x32_bf16 v[112:115], v[80:83], v[60:63], v[112:115]
  s_waitcnt lgkmcnt(6)
  v_mfma_f32_16x16x32_bf16 v[128:131], v[84:87], v[60:63], v[128:131]
  ds_read_b64_tr_b16 v[80:81], v3 offset:32768
  v_mfma_f32_16x16x32_bf16 v[132:135], v[84:87], v[64:67], v[132:135]
  ds_read_b64_tr_b16 v[82:83], v3 offset:33280
  v_mfma_f32_16x16x32_bf16 v[136:139], v[84:87], v[68:71], v[136:139]
  s_add_u32 m0, s22, 135168
  s_nop 0
  buffer_load_dwordx4 v7, s[8:11], s20 offen offset:0 nt lds
  v_mfma_f32_16x16x32_bf16 v[140:143], v[84:87], v[72:75], v[140:143]
  s_waitcnt lgkmcnt(6)
  v_mfma_f32_16x16x32_bf16 v[156:159], v[88:91], v[72:75], v[156:159]
  ds_read_b64_tr_b16 v[84:85], v4 offset:32768
  v_mfma_f32_16x16x32_bf16 v[152:155], v[88:91], v[68:71], v[152:155]
  ds_read_b64_tr_b16 v[86:87], v4 offset:33280
  v_mfma_f32_16x16x32_bf16 v[148:151], v[88:91], v[64:67], v[148:151]
  s_add_u32 m0, s22, 139136
  s_nop 0
  buffer_load_dwordx4 v7, s[8:11], s20 offen offset:128 nt lds
  v_mfma_f32_16x16x32_bf16 v[144:147], v[88:91], v[60:63], v[144:147]
  s_waitcnt lgkmcnt(6)
  v_mfma_f32_16x16x32_bf16 v[160:163], v[92:95], v[60:63], v[160:163]
  ds_read_b64_tr_b16 v[88:89], v3 offset:36864
  v_mfma_f32_16x16x32_bf16 v[164:167], v[92:95], v[64:67], v[164:167]
  ds_read_b64_tr_b16 v[90:91], v3 offset:37376
  v_mfma_f32_16x16x32_bf16 v[168:171], v[92:95], v[68:71], v[168:171]
  s_add_u32 m0, s22, 143360
  s_nop 0
  buffer_load_dwordx4 v8, s[12:15], s21 offen offset:0 nt lds
  s_add_u32 s20, s20, 229376
  s_add_u32 s21, s21, 196608
  buffer_load_dwordx4 v[16:19], v9, s[52:55], s50 offen nt
  s_add_u32 s50, s50, 4096
  v_mfma_f32_16x16x32_bf16 v[172:175], v[92:95], v[72:75], v[172:175]
  s_waitcnt lgkmcnt(6)
  v_mfma_f32_16x16x32_bf16 v[188:191], v[76:79], v[72:75], v[188:191]
  ds_read_b64_tr_b16 v[92:93], v4 offset:36864
  v_mfma_f32_16x16x32_bf16 v[184:187], v[76:79], v[68:71], v[184:187]
  ds_read_b64_tr_b16 v[94:95], v4 offset:37376
  v_mfma_f32_16x16x32_bf16 v[180:183], v[76:79], v[64:67], v[180:183]
  v_mfma_f32_16x16x32_bf16 v[176:179], v[76:79], v[60:63], v[176:179]
  s_waitcnt vmcnt(7) lgkmcnt(6)
  s_barrier
  v_mfma_f32_16x16x32_bf16 v[192:195], v[80:83], v[60:63], v[192:195]
  ds_read_b64_tr_b16 v[76:77], v5 offset:0
  v_mfma_f32_16x16x32_bf16 v[196:199], v[80:83], v[64:67], v[196:199]
  ds_read_b64_tr_b16 v[78:79], v5 offset:512
  v_mfma_f32_16x16x32_bf16 v[200:203], v[80:83], v[68:71], v[200:203]
  ds_read_b128 v[44:47], v2 offset:32768
  v_mfma_f32_16x16x32_bf16 v[204:207], v[80:83], v[72:75], v[204:207]
  ds_read_b128 v[48:51], v2 offset:33792
  s_waitcnt lgkmcnt(8)
  v_mfma_f32_16x16x32_bf16 v[220:223], v[84:87], v[72:75], v[220:223]
  ds_read_b64_tr_b16 v[80:81], v6 offset:0
  v_mfma_f32_16x16x32_bf16 v[216:219], v[84:87], v[68:71], v[216:219]
  ds_read_b64_tr_b16 v[82:83], v6 offset:512
  v_mfma_f32_16x16x32_bf16 v[212:215], v[84:87], v[64:67], v[212:215]
  ds_read_b128 v[52:55], v2 offset:34816
  v_mfma_f32_16x16x32_bf16 v[208:211], v[84:87], v[60:63], v[208:211]
  ds_read_b128 v[56:59], v2 offset:35840
  s_waitcnt lgkmcnt(10)
  v_mfma_f32_16x16x32_bf16 v[224:227], v[88:91], v[60:63], v[224:227]
  ds_read_b64_tr_b16 v[84:85], v5 offset:4096
  v_mfma_f32_16x16x32_bf16 v[228:231], v[88:91], v[64:67], v[228:231]
  ds_read_b64_tr_b16 v[86:87], v5 offset:4608
  v_mfma_f32_16x16x32_bf16 v[232:235], v[88:91], v[68:71], v[232:235]
  v_mfma_f32_16x16x32_bf16 v[236:239], v[88:91], v[72:75], v[236:239]
  s_waitcnt lgkmcnt(10)
  v_mfma_f32_16x16x32_bf16 v[252:255], v[92:95], v[72:75], v[252:255]
  ds_read_b64_tr_b16 v[88:89], v6 offset:4096
  v_mfma_f32_16x16x32_bf16 v[248:251], v[92:95], v[68:71], v[248:251]
  ds_read_b64_tr_b16 v[90:91], v6 offset:4608
  v_mfma_f32_16x16x32_bf16 v[244:247], v[92:95], v[64:67], v[244:247]
  v_mfma_f32_16x16x32_bf16 v[240:243], v[92:95], v[60:63], v[240:243]
  s_waitcnt lgkmcnt(4)
  v_mfma_f32_16x16x32_bf16 v[96:99], v[76:79], v[44:47], v[96:99]
  ds_read_b64_tr_b16 v[92:93], v5 offset:8192
  v_mfma_f32_16x16x32_bf16 v[100:103], v[76:79], v[48:51], v[100:103]
  ds_read_b64_tr_b16 v[94:95], v5 offset:8704
  v_mfma_f32_16x16x32_bf16 v[104:107], v[76:79], v[52:55], v[104:107]
  s_add_u32 m0, s22, 65536
  s_nop 0
  buffer_load_dwordx4 v7, s[4:7], s20 offen offset:0 nt lds
  v_mfma_f32_16x16x32_bf16 v[108:111], v[76:79], v[56:59], v[108:111]
  v_mfma_f32_16x16x32_bf16 v[124:127], v[80:83], v[56:59], v[124:127]
  ds_read_b64_tr_b16 v[76:77], v6 offset:8192
  v_mfma_f32_16x16x32_bf16 v[120:123], v[80:83], v[52:55], v[120:123]
  ds_read_b64_tr_b16 v[78:79], v6 offset:8704
  v_mfma_f32_16x16x32_bf16 v[116:119], v[80:83], v[48:51], v[116:119]
  s_add_u32 m0, s22, 69504
  s_nop 0
  buffer_load_dwordx4 v7, s[4:7], s20 offen offset:128 nt lds
  v_mfma_f32_16x16x32_bf16 v[112:115], v[80:83], v[44:47], v[112:115]
  s_waitcnt lgkmcnt(6)
  v_mfma_f32_16x16x32_bf16 v[128:131], v[84:87], v[44:47], v[128:131]
  ds_read_b64_tr_b16 v[80:81], v5 offset:12288
  v_mfma_f32_16x16x32_bf16 v[132:135], v[84:87], v[48:51], v[132:135]
  ds_read_b64_tr_b16 v[82:83], v5 offset:12800
  v_mfma_f32_16x16x32_bf16 v[136:139], v[84:87], v[52:55], v[136:139]
  s_add_u32 m0, s22, 73728
  s_nop 0
  buffer_load_dwordx4 v7, s[8:11], s20 offen offset:0 nt lds
  v_mfma_f32_16x16x32_bf16 v[140:143], v[84:87], v[56:59], v[140:143]
  s_waitcnt lgkmcnt(6)
  v_mfma_f32_16x16x32_bf16 v[156:159], v[88:91], v[56:59], v[156:159]
  ds_read_b64_tr_b16 v[84:85], v6 offset:12288
  v_mfma_f32_16x16x32_bf16 v[152:155], v[88:91], v[52:55], v[152:155]
  ds_read_b64_tr_b16 v[86:87], v6 offset:12800
  v_mfma_f32_16x16x32_bf16 v[148:151], v[88:91], v[48:51], v[148:151]
  s_add_u32 m0, s22, 77696
  s_nop 0
  buffer_load_dwordx4 v7, s[8:11], s20 offen offset:128 nt lds
  v_mfma_f32_16x16x32_bf16 v[144:147], v[88:91], v[44:47], v[144:147]
  s_waitcnt lgkmcnt(6)
  v_mfma_f32_16x16x32_bf16 v[160:163], v[92:95], v[44:47], v[160:163]
  ds_read_b64_tr_b16 v[88:89], v5 offset:16384
  v_mfma_f32_16x16x32_bf16 v[164:167], v[92:95], v[48:51], v[164:167]
  ds_read_b64_tr_b16 v[90:91], v5 offset:16896
  v_mfma_f32_16x16x32_bf16 v[168:171], v[92:95], v[52:55], v[168:171]
  s_add_u32 m0, s22, 81920
  s_nop 0
  buffer_load_dwordx4 v8, s[12:15], s21 offen offset:0 nt lds
  s_add_u32 s20, s20, 229376
  s_add_u32 s21, s21, 196608
  v_mfma_f32_16x16x32_bf16 v[172:175], v[92:95], v[56:59], v[172:175]
  s_waitcnt lgkmcnt(6)
  v_mfma_f32_16x16x32_bf16 v[188:191], v[76:79], v[56:59], v[188:191]
  ds_read_b64_tr_b16 v[92:93], v6 offset:16384
  v_mfma_f32_16x16x32_bf16 v[184:187], v[76:79], v[52:55], v[184:187]
  ds_read_b64_tr_b16 v[94:95], v6 offset:16896
  v_mfma_f32_16x16x32_bf16 v[180:183], v[76:79], v[48:51], v[180:183]
  v_mfma_f32_16x16x32_bf16 v[176:179], v[76:79], v[44:47], v[176:179]
  s_waitcnt vmcnt(6) lgkmcnt(6)
  s_barrier
  v_mfma_f32_16x16x32_bf16 v[192:195], v[80:83], v[44:47], v[192:195]
  ds_read_b64_tr_b16 v[76:77], v5 offset:20480
  v_mfma_f32_16x16x32_bf16 v[196:199], v[80:83], v[48:51], v[196:199]
  ds_read_b64_tr_b16 v[78:79], v5 offset:20992
  v_mfma_f32_16x16x32_bf16 v[200:203], v[80:83], v[52:55], v[200:203]
  ds_read_b128 v[60:63], v2 offset:49152
  v_mfma_f32_16x16x32_bf16 v[204:207], v[80:83], v[56:59], v[204:207]
  ds_read_b128 v[64:67], v2 offset:50176
  s_waitcnt lgkmcnt(8)
  v_mfma_f32_16x16x32_bf16 v[220:223], v[84:87], v[56:59], v[220:223]
  ds_read_b64_tr_b16 v[80:81], v6 offset:20480
  v_mfma_f32_16x16x32_bf16 v[216:219], v[84:87], v[52:55], v[216:219]
  ds_read_b64_tr_b16 v[82:83], v6 offset:20992
  v_mfma_f32_16x16x32_bf16 v[212:215], v[84:87], v[48:51], v[212:215]
  ds_read_b128 v[68:71], v2 offset:51200
  v_mfma_f32_16x16x32_bf16 v[208:211], v[84:87], v[44:47], v[208:211]
  ds_read_b128 v[72:75], v2 offset:52224
  s_waitcnt lgkmcnt(10)
  v_mfma_f32_16x16x32_bf16 v[224:227], v[88:91], v[44:47], v[224:227]
  ds_read_b64_tr_b16 v[84:85], v5 offset:24576
  v_mfma_f32_16x16x32_bf16 v[228:231], v[88:91], v[48:51], v[228:231]
  ds_read_b64_tr_b16 v[86:87], v5 offset:25088
  v_mfma_f32_16x16x32_bf16 v[232:235], v[88:91], v[52:55], v[232:235]
  v_mfma_f32_16x16x32_bf16 v[236:239], v[88:91], v[56:59], v[236:239]
  s_waitcnt lgkmcnt(10)
  v_mfma_f32_16x16x32_bf16 v[252:255], v[92:95], v[56:59], v[252:255]
  ds_read_b64_tr_b16 v[88:89], v6 offset:24576
  v_mfma_f32_16x16x32_bf16 v[248:251], v[92:95], v[52:55], v[248:251]
  ds_read_b64_tr_b16 v[90:91], v6 offset:25088
  v_mfma_f32_16x16x32_bf16 v[244:247], v[92:95], v[48:51], v[244:247]
  v_mfma_f32_16x16x32_bf16 v[240:243], v[92:95], v[44:47], v[240:243]
  s_waitcnt lgkmcnt(4)
  v_mfma_f32_16x16x32_bf16 v[96:99], v[76:79], v[60:63], v[96:99]
  ds_read_b64_tr_b16 v[92:93], v5 offset:28672
  v_mfma_f32_16x16x32_bf16 v[100:103], v[76:79], v[64:67], v[100:103]
  ds_read_b64_tr_b16 v[94:95], v5 offset:29184
  v_mfma_f32_16x16x32_bf16 v[104:107], v[76:79], v[68:71], v[104:107]
  s_add_u32 m0, s22, 86016
  s_nop 0
  buffer_load_dwordx4 v7, s[4:7], s20 offen offset:0 nt lds
  v_mfma_f32_16x16x32_bf16 v[108:111], v[76:79], v[72:75], v[108:111]
  v_mfma_f32_16x16x32_bf16 v[124:127], v[80:83], v[72:75], v[124:127]
  ds_read_b64_tr_b16 v[76:77], v6 offset:28672
  v_mfma_f32_16x16x32_bf16 v[120:123], v[80:83], v[68:71], v[120:123]
  ds_read_b64_tr_b16 v[78:79], v6 offset:29184
  v_mfma_f32_16x16x32_bf16 v[116:119], v[80:83], v[64:67], v[116:119]
  s_add_u32 m0, s22, 89984
  s_nop 0
  buffer_load_dwordx4 v7, s[4:7], s20 offen offset:128 nt lds
  v_mfma_f32_16x16x32_bf16 v[112:115], v[80:83], v[60:63], v[112:115]
  s_waitcnt lgkmcnt(6)
  v_mfma_f32_16x16x32_bf16 v[128:131], v[84:87], v[60:63], v[128:131]
  ds_read_b64_tr_b16 v[80:81], v5 offset:32768
  v_mfma_f32_16x16x32_bf16 v[132:135], v[84:87], v[64:67], v[132:135]
  ds_read_b64_tr_b16 v[82:83], v5 offset:33280
  v_mfma_f32_16x16x32_bf16 v[136:139], v[84:87], v[68:71], v[136:139]
  s_add_u32 m0, s22, 94208
  s_nop 0
  buffer_load_dwordx4 v7, s[8:11], s20 offen offset:0 nt lds
  v_mfma_f32_16x16x32_bf16 v[140:143], v[84:87], v[72:75], v[140:143]
  s_waitcnt lgkmcnt(6)
  v_mfma_f32_16x16x32_bf16 v[156:159], v[88:91], v[72:75], v[156:159]
  ds_read_b64_tr_b16 v[84:85], v6 offset:32768
  v_mfma_f32_16x16x32_bf16 v[152:155], v[88:91], v[68:71], v[152:155]
  ds_read_b64_tr_b16 v[86:87], v6 offset:33280
  v_mfma_f32_16x16x32_bf16 v[148:151], v[88:91], v[64:67], v[148:151]
  s_add_u32 m0, s22, 98176
  s_nop 0
  buffer_load_dwordx4 v7, s[8:11], s20 offen offset:128 nt lds
  v_mfma_f32_16x16x32_bf16 v[144:147], v[88:91], v[60:63], v[144:147]
  s_waitcnt lgkmcnt(6)
  v_mfma_f32_16x16x32_bf16 v[160:163], v[92:95], v[60:63], v[160:163]
  ds_read_b64_tr_b16 v[88:89], v5 offset:36864
  v_mfma_f32_16x16x32_bf16 v[164:167], v[92:95], v[64:67], v[164:167]
  ds_read_b64_tr_b16 v[90:91], v5 offset:37376
  v_mfma_f32_16x16x32_bf16 v[168:171], v[92:95], v[68:71], v[168:171]
  s_add_u32 m0, s22, 102400
  s_nop 0
  buffer_load_dwordx4 v8, s[12:15], s21 offen offset:0 nt lds
  s_add_u32 s20, s20, 229376
  s_add_u32 s21, s21, 196608
  v_mfma_f32_16x16x32_bf16 v[172:175], v[92:95], v[72:75], v[172:175]
  s_waitcnt lgkmcnt(6)
  v_mfma_f32_16x16x32_bf16 v[188:191], v[76:79], v[72:75], v[188:191]
  ds_read_b64_tr_b16 v[92:93], v6 offset:36864
  v_mfma_f32_16x16x32_bf16 v[184:187], v[76:79], v[68:71], v[184:187]
  ds_read_b64_tr_b16 v[94:95], v6 offset:37376
  v_mfma_f32_16x16x32_bf16 v[180:183], v[76:79], v[64:67], v[180:183]
  v_mfma_f32_16x16x32_bf16 v[176:179], v[76:79], v[60:63], v[176:179]
  s_waitcnt vmcnt(5) lgkmcnt(6)
  s_barrier
  v_mfma_f32_16x16x32_bf16 v[192:195], v[80:83], v[60:63], v[192:195]
  ds_read_b64_tr_b16 v[76:77], v3 offset:0
  v_mfma_f32_16x16x32_bf16 v[196:199], v[80:83], v[64:67], v[196:199]
  ds_read_b64_tr_b16 v[78:79], v3 offset:512
  v_mfma_f32_16x16x32_bf16 v[200:203], v[80:83], v[68:71], v[200:203]
  ds_read_b128 v[44:47], v2 offset:0
  v_mfma_f32_16x16x32_bf16 v[204:207], v[80:83], v[72:75], v[204:207]
  ds_read_b128 v[48:51], v2 offset:1024
  s_waitcnt lgkmcnt(8)
  v_mfma_f32_16x16x32_bf16 v[220:223], v[84:87], v[72:75], v[220:223]
  ds_read_b64_tr_b16 v[80:81], v4 offset:0
  v_mfma_f32_16x16x32_bf16 v[216:219], v[84:87], v[68:71], v[216:219]
  ds_read_b64_tr_b16 v[82:83], v4 offset:512
  v_mfma_f32_16x16x32_bf16 v[212:215], v[84:87], v[64:67], v[212:215]
  ds_read_b128 v[52:55], v2 offset:2048
  v_mfma_f32_16x16x32_bf16 v[208:211], v[84:87], v[60:63], v[208:211]
  ds_read_b128 v[56:59], v2 offset:3072
  s_waitcnt lgkmcnt(10)
  v_mfma_f32_16x16x32_bf16 v[224:227], v[88:91], v[60:63], v[224:227]
  ds_read_b64_tr_b16 v[84:85], v3 offset:4096
  v_mfma_f32_16x16x32_bf16 v[228:231], v[88:91], v[64:67], v[228:231]
  ds_read_b64_tr_b16 v[86:87], v3 offset:4608
  v_mfma_f32_16x16x32_bf16 v[232:235], v[88:91], v[68:71], v[232:235]
  v_mfma_f32_16x16x32_bf16 v[236:239], v[88:91], v[72:75], v[236:239]
  s_waitcnt lgkmcnt(10)
  v_mfma_f32_16x16x32_bf16 v[252:255], v[92:95], v[72:75], v[252:255]
  ds_read_b64_tr_b16 v[88:89], v4 offset:4096
  v_mfma_f32_16x16x32_bf16 v[248:251], v[92:95], v[68:71], v[248:251]
  ds_read_b64_tr_b16 v[90:91], v4 offset:4608
  v_mfma_f32_16x16x32_bf16 v[244:247], v[92:95], v[64:67], v[244:247]
  v_mfma_f32_16x16x32_bf16 v[240:243], v[92:95], v[60:63], v[240:243]
  s_sub_u32 s24, s24, 1
  s_cmp_lg_u32 s24, 0
  s_cbranch_scc1 k2_loop_Aw
  s_branch mega_epi
mega_wC:
  s_waitcnt vmcnt(5)
  s_barrier
  ds_read_b64_tr_b16 v[76:77], v3 offset:0
  ds_read_b64_tr_b16 v[78:79], v3 offset:512
  ds_read_b128 v[44:47], v2 offset:0
  ds_read_b128 v[48:51], v2 offset:1024
  ds_read_b64_tr_b16 v[80:81], v4 offset:0
  ds_read_b64_tr_b16 v[82:83], v4 offset:512
  ds_read_b128 v[52:55], v2 offset:2048
  ds_read_b128 v[56:59], v2 offset:3072
  ds_read_b64_tr_b16 v[84:85], v3 offset:4096
  ds_read_b64_tr_b16 v[86:87], v3 offset:4608
  ds_read_b64_tr_b16 v[88:89], v4 offset:4096
  ds_read_b64_tr_b16 v[90:91], v4 offset:4608
  s_mov_b32 s35, 64
  s_mov_b32 s24, 8
.p2align 6
k2_loop_Cw:
  s_waitcnt lgkmcnt(4)
  v_mfma_f32_16x16x32_bf16 v[96:99], v[76:79], v[44:47], v[96:99]
  ds_read_b64_tr_b16 v[92:93], v3 offset:8192
  v_mfma_f32_16x16x32_bf16 v[100:103], v[76:79], v[48:51], v[100:103]
  ds_read_b64_tr_b16 v[94:95], v3 offset:8704
  v_mfma_f32_16x16x32_bf16 v[104:107], v[76:79], v[52:55], v[104:107]
  s_add_u32 m0, s22, 106496
  s_nop 0
  buffer_load_dwordx4 v7, s[4:7], s20 offen offset:0 nt lds
  v_mfma_f32_16x16x32_bf16 v[108:111], v[76:79], v[56:59], v[108:111]
  v_mfma_f32_16x16x32_bf16 v[124:127], v[80:83], v[56:59], v[124:127]
  ds_read_b64_tr_b16 v[76:77], v4 offset:8192
  v_mfma_f32_16x16x32_bf16 v[120:123], v[80:83], v[52:55], v[120:123]
  ds_read_b64_tr_b16 v[78:79], v4 offset:8704
  v_mfma_f32_16x16x32_bf16 v[116:119], v[80:83], v[48:51], v[116:119]
  s_add_u32 m0, s22, 110592
  s_nop 0
  buffer_load_dwordx4 v8, s[44:47], s21 offen offset:0 nt lds
  v_mfma_f32_16x16x32_bf16 v[112:115], v[80:83], v[44:47], v[112:115]
  s_waitcnt lgkmcnt(6)
  v_mfma_f32_16x16x32_bf16 v[128:131], v[44:47], v[84:87], v[128:131]
  ds_read_b64_tr_b16 v[80:81], v3 offset:12288
  v_mfma_f32_16x16x32_bf16 v[132:135], v[48:51], v[84:87], v[132:135]
  ds_read_b64_tr_b16 v[82:83], v3 offset:12800
  v_mfma_f32_16x16x32_bf16 v[136:139], v[52:55], v[84:87], v[136:139]
  s_add_u32 m0, s22, 114688
  s_nop 0
  buffer_load_dwordx4 v7, s[8:11], s20 offen offset:0 nt lds
  v_mfma_f32_16x16x32_bf16 v[140:143], v[56:59], v[84:87], v[140:143]
  s_waitcnt lgkmcnt(6)
  v_mfma_f32_16x16x32_bf16 v[156:159], v[56:59], v[88:91], v[156:159]
  ds_read_b64_tr_b16 v[84:85], v4 offset:12288
  v_mfma_f32_16x16x32_bf16 v[152:155], v[52:55], v[88:91], v[152:155]
  ds_read_b64_tr_b16 v[86:87], v4 offset:12800
  v_mfma_f32_16x16x32_bf16 v[148:151], v[48:51], v[88:91], v[148:151]
  s_add_u32 m0, s22, 118656
  s_nop 0
  buffer_load_dwordx4 v8, s[44:47], s21 offen offset:128 nt lds
  v_mfma_f32_16x16x32_bf16 v[144:147], v[44:47], v[88:91], v[144:147]
  s_waitcnt lgkmcnt(6)
  v_mfma_f32_16x16x32_bf16 v[160:163], v[92:95], v[44:47], v[160:163]
  ds_read_b64_tr_b16 v[88:89], v3 offset:16384
  v_mfma_f32_16x16x32_bf16 v[164:167], v[92:95], v[48:51], v[164:167]
  ds_read_b64_tr_b16 v[90:91], v3 offset:16896
  v_mfma_f32_16x16x32_bf16 v[168:171], v[92:95], v[52:55], v[168:171]
  s_add_u32 m0, s22, 122880
  s_nop 0
  buffer_load_dwordx4 v8, s[12:15], s21 offen offset:0 nt lds
  s_add_u32 s20, s20, 229376
  s_add_u32 s21, s21, 196608
  s_and_b32 s31, s35, 0x40
  v_xor_b32 v15, s31, v14
  s_add_u32 s35, s35, 64
  s_bitcmp1_b32 0xc0, s24
  s_cselect_b32 s31, s62, 0x7f000000
  buffer_store_dwordx4 v[16:19], v15, s[56:59], s31 offen sc1
  s_add_u32 s62, s62, 256
  v_mfma_f32_16x16x32_bf16 v[172:175], v[92:95], v[56:59], v[172:175]
  s_waitcnt lgkmcnt(6)
  v_mfma_f32_16x16x32_bf16 v[188:191], v[76:79], v[56:59], v[188:191]
  ds_read_b64_tr_b16 v[92:93], v4 offset:16384
  v_mfma_f32_16x16x32_bf16 v[184:187], v[76:79], v[52:55], v[184:187]
  ds_read_b64_tr_b16 v[94:95], v4 offset:16896
  v_mfma_f32_16x16x32_bf16 v[180:183], v[76:79], v[48:51], v[180:183]
  v_mfma_f32_16x16x32_bf16 v[176:179], v[76:79], v[44:47], v[176:179]
  s_waitcnt vmcnt(6) lgkmcnt(6)
  s_barrier
  v_mfma_f32_16x16x32_bf16 v[192:195], v[44:47], v[80:83], v[192:195]
  ds_read_b64_tr_b16 v[76:77], v3 offset:20480
  v_mfma_f32_16x16x32_bf16 v[196:199], v[48:51], v[80:83], v[196:199]
  ds_read_b64_tr_b16 v[78:79], v3 offset:20992
  v_mfma_f32_16x16x32_bf16 v[200:203], v[52:55], v[80:83], v[200:203]
  ds_read_b128 v[60:63], v2 offset:16384
  v_mfma_f32_16x16x32_bf16 v[204:207], v[56:59], v[80:83], v[204:207]
  ds_read_b128 v[64:67], v2 offset:17408
  s_waitcnt lgkmcnt(8)
  v_mfma_f32_16x16x32_bf16 v[220:223], v[56:59], v[84:87], v[220:223]
  ds_read_b64_tr_b16 v[80:81], v4 offset:20480
  v_mfma_f32_16x16x32_bf16 v[216:219], v[52:55], v[84:87], v[216:219]
  ds_read_b64_tr_b16 v[82:83], v4 offset:20992
  v_mfma_f32_16x16x32_bf16 v[212:215], v[48:51], v[84:87], v[212:215]
  ds_read_b128 v[68:71], v2 offset:18432
  v_mfma_f32_16x16x32_bf16 v[208:211], v[44:47], v[84:87], v[208:211]
  ds_read_b128 v[72:75], v2 offset:19456
  s_waitcnt lgkmcnt(10)
  v_mfma_f32_16x16x32_bf16 v[224:227], v[88:91], v[44:47], v[224:227]
  ds_read_b64_tr_b16 v[84:85], v3 offset:24576
  v_mfma_f32_16x16x32_bf16 v[228:231], v[88:91], v[48:51], v[228:231]
  ds_read_b64_tr_b16 v[86:87], v3 offset:25088
  v_mfma_f32_16x16x32_bf16 v[232:235], v[88:91], v[52:55], v[232:235]
  v_mfma_f32_16x16x32_bf16 v[236:239], v[88:91], v[56:59], v[236:239]
  s_waitcnt lgkmcnt(10)
  v_mfma_f32_16x16x32_bf16 v[252:255], v[92:95], v[56:59], v[252:255]
  ds_read_b64_tr_b16 v[88:89], v4 offset:24576
  v_mfma_f32_16x16x32_bf16 v[248:251], v[92:95], v[52:55], v[248:251]
  ds_read_b64_tr_b16 v[90:91], v4 offset:25088
  v_mfma_f32_16x16x32_bf16 v[244:247], v[92:95], v[48:51], v[244:247]
  v_mfma_f32_16x16x32_bf16 v[240:243], v[92:95], v[44:47], v[240:243]
  s_waitcnt lgkmcnt(4)
  v_mfma_f32_16x16x32_bf16 v[96:99], v[76:79], v[60:63], v[96:99]
  ds_read_b64_tr_b16 v[92:93], v3 offset:28672
  v_mfma_f32_16x16x32_bf16 v[100:103], v[76:79], v[64:67], v[100:103]
  ds_read_b64_tr_b16 v[94:95], v3 offset:29184
  v_mfma_f32_16x16x32_bf16 v[104:107], v[76:79], v[68:71], v[104:107]
  s_add_u32 m0, s22, 126976
  s_nop 0
  buffer_load_dwordx4 v7, s[4:7], s20 offen offset:0 nt lds
  v_mfma_f32_16x16x32_bf16 v[108:111], v[76:79], v[72:75], v[108:111]
  v_mfma_f32_16x16x32_bf16 v[124:127], v[80:83], v[72:75], v[124:127]
  ds_read_b64_tr_b16 v[76:77], v4 offset:28672
  v_mfma_f32_16x16x32_bf16 v[120:123], v[80:83], v[68:71], v[120:123]
  ds_read_b64_tr_b16 v[78:79], v4 offset:29184
  v_mfma_f32_16x16x32_bf16 v[116:119], v[80:83], v[64:67], v[116:119]
  s_add_u32 m0, s22, 131072
  s_nop 0
  buffer_load_dwordx4 v8, s[44:47], s21 offen offset:0 nt lds
  v_mfma_f32_16x16x32_bf16 v[112:115], v[80:83], v[60:63], v[112:115]
  s_waitcnt lgkmcnt(6)
  v_mfma_f32_16x16x32_bf16 v[128:131], v[60:63], v[84:87], v[128:131]
  ds_read_b64_tr_b16 v[80:81], v3 offset:32768
  v_mfma_f32_16x16x32_bf16 v[132:135], v[64:67], v[84:87], v[132:135]
  ds_read_b64_tr_b16 v[82:83], v3 offset:33280
  v_mfma_f32_16x16x32_bf16 v[136:139], v[68:71], v[84:87], v[136:139]
  s_add_u32 m0, s22, 135168
  s_nop 0
  buffer_load_dwordx4 v7, s[8:11], s20 offen offset:0 nt lds
  v_mfma_f32_16x16x32_bf16 v[140:143], v[72:75], v[84:87], v[140:143]
  s_waitcnt lgkmcnt(6)
  v_mfma_f32_16x16x32_bf16 v[156:159], v[72:75], v[88:91], v[156:159]
  ds_read_b64_tr_b16 v[84:85], v4 offset:32768
  v_mfma_f32_16x16x32_bf16 v[152:155], v[68:71], v[88:91], v[152:155]
  ds_read_b64_tr_b16 v[86:87], v4 offset:33280
  v_mfma_f32_16x16x32_bf16 v[148:151], v[64:67], v[88:91], v[148:151]
  s_add_u32 m0, s22, 139136
  s_nop 0
  buffer_load_dwordx4 v8, s[44:47], s21 offen offset:128 nt lds
  v_mfma_f32_16x16x32_bf16 v[144:147], v[60:63], v[88:91], v[144:147]
  s_waitcnt lgkmcnt(6)
  v_mfma_f32_16x16x32_bf16 v[160:163], v[92:95], v[60:63], v[160:163]
  ds_read_b64_tr_b16 v[88:89], v3 offset:36864
  v_mfma_f32_16x16x32_bf16 v[164:167], v[92:95], v[64:67], v[164:167]
  ds_read_b64_tr_b16 v[90:91], v3 offset:37376
  v_mfma_f32_16x16x32_bf16 v[168:171], v[92:95], v[68:71], v[168:171]
  s_add_u32 m0, s22, 143360
  s_nop 0
  buffer_load_dwordx4 v8, s[12:15], s21 offen offset:0 nt lds
  s_add_u32 s20, s20, 229376
  s_add_u32 s21, s21, 196608
  buffer_load_dwordx4 v[16:19], v9, s[52:55], s50 offen nt
  s_add_u32 s50, s50, 4096
  v_mfma_f32_16x16x32_bf16 v[172:175], v[92:95], v[72:75], v[172:175]
  s_waitcnt lgkmcnt(6)
  v_mfma_f32_16x16x32_bf16 v[188:191], v[76:79], v[72:75], v[188:191]
  ds_read_b64_tr_b16 v[92:93], v4 offset:36864
  v_mfma_f32_16x16x32_bf16 v[184:187], v[76:79], v[68:71], v[184:187]
  ds_read_b64_tr_b16 v[94:95], v4 offset:37376
  v_mfma_f32_16x16x32_bf16 v[180:183], v[76:79], v[64:67], v[180:183]
  v_mfma_f32_16x16x32_bf16 v[176:179], v[76:79], v[60:63], v[176:179]
  s_waitcnt vmcnt(7) lgkmcnt(6)
  s_barrier
  v_mfma_f32_16x16x32_bf16 v[192:195], v[60:63], v[80:83], v[192:195]
  ds_read_b64_tr_b16 v[76:77], v5 offset:0
  v_mfma_f32_16x16x32_bf16 v[196:199], v[64:67], v[80:83], v[196:199]
  ds_read_b64_tr_b16 v[78:79], v5 offset:512
  v_mfma_f32_16x16x32_bf16 v[200:203], v[68:71], v[80:83], v[200:203]
  ds_read_b128 v[44:47], v2 offset:32768
  v_mfma_f32_16x16x32_bf16 v[204:207], v[72:75], v[80:83], v[204:207]
  ds_read_b128 v[48:51], v2 offset:33792
  s_waitcnt lgkmcnt(8)
  v_mfma_f32_16x16x32_bf16 v[220:223], v[72:75], v[84:87], v[220:223]
  ds_read_b64_tr_b16 v[80:81], v6 offset:0
  v_mfma_f32_16x16x32_bf16 v[216:219], v[68:71], v[84:87], v[216:219]
  ds_read_b64_tr_b16 v[82:83], v6 offset:512
  v_mfma_f32_16x16x32_bf16 v[212:215], v[64:67], v[84:87], v[212:215]
  ds_read_b128 v[52:55], v2 offset:34816
  v_mfma_f32_16x16x32_bf16 v[208:211], v[60:63], v[84:87], v[208:211]
  ds_read_b128 v[56:59], v2 offset:35840
  s_waitcnt lgkmcnt(10)
  v_mfma_f32_16x16x32_bf16 v[224:227], v[88:91], v[60:63], v[224:227]
  ds_read_b64_tr_b16 v[84:85], v5 offset:4096
  v_mfma_f32_16x16x32_bf16 v[228:231], v[88:91], v[64:67], v[228:231]
  ds_read_b64_tr_b16 v[86:87], v5 offset:4608
  v_mfma_f32_16x16x32_bf16 v[232:235], v[88:91], v[68:71], v[232:235]
  v_mfma_f32_16x16x32_bf16 v[236:239], v[88:91], v[72:75], v[236:239]
  s_waitcnt lgkmcnt(10)
  v_mfma_f32_16x16x32_bf16 v[252:255], v[92:95], v[72:75], v[252:255]
  ds_read_b64_tr_b16 v[88:89], v6 offset:4096
  v_mfma_f32_16x16x32_bf16 v[248:251], v[92:95], v[68:71], v[248:251]
  ds_read_b64_tr_b16 v[90:91], v6 offset:4608
  v_mfma_f32_16x16x32_bf16 v[244:247], v[92:95], v[64:67], v[244:247]
  v_mfma_f32_16x16x32_bf16 v[240:243], v[92:95], v[60:63], v[240:243]
  s_waitcnt lgkmcnt(4)
  v_mfma_f32_16x16x32_bf16 v[96:99], v[76:79], v[44:47], v[96:99]
  ds_read_b64_tr_b16 v[92:93], v5 offset:8192
  v_mfma_f32_16x16x32_bf16 v[100:103], v[76:79], v[48:51], v[100:103]
  ds_read_b64_tr_b16 v[94:95], v5 offset:8704
  v_mfma_f32_16x16x32_bf16 v[104:107], v[76:79], v[52:55], v[104:107]
  s_add_u32 m0, s22, 65536
  s_nop 0
  buffer_load_dwordx4 v7, s[4:7], s20 offen offset:0 nt lds
  v_mfma_f32_16x16x32_bf16 v[108:111], v[76:79], v[56:59], v[108:111]
  v_mfma_f32_16x16x32_bf16 v[124:127], v[80:83], v[56:59], v[124:127]
  ds_read_b64_tr_b16 v[76:77], v6 offset:8192
  v_mfma_f32_16x16x32_bf16 v[120:123], v[80:83], v[52:55], v[120:123]
  ds_read_b64_tr_b16 v[78:79], v6 offset:8704
  v_mfma_f32_16x16x32_bf16 v[116:119], v[80:83], v[48:51], v[116:119]
  s_add_u32 m0, s22, 69632
  s_nop 0
  buffer_load_dwordx4 v8, s[44:47], s21 offen offset:0 nt lds
  v_mfma_f32_16x16x32_bf16 v[112:115], v[80:83], v[44:47], v[112:115]
  s_waitcnt lgkmcnt(6)
  v_mfma_f32_16x16x32_bf16 v[128:131], v[44:47], v[84:87], v[128:131]
  ds_read_b64_tr_b16 v[80:81], v5 offset:12288
  v_mfma_f32_16x16x32_bf16 v[132:135], v[48:51], v[84:87], v[132:135]
  ds_read_b64_tr_b16 v[82:83], v5 offset:12800
  v_mfma_f32_16x16x32_bf16 v[136:139], v[52:55], v[84:87], v[136:139]
  s_add_u32 m0, s22, 73728
  s_nop 0
  buffer_load_dwordx4 v7, s[8:11], s20 offen offset:0 nt lds
  v_mfma_f32_16x16x32_bf16 v[140:143], v[56:59], v[84:87], v[140:143]
  s_waitcnt lgkmcnt(6)
  v_mfma_f32_16x16x32_bf16 v[156:159], v[56:59], v[88:91], v[156:159]
  ds_read_b64_tr_b16 v[84:85], v6 offset:12288
  v_mfma_f32_16x16x32_bf16 v[152:155], v[52:55], v[88:91], v[152:155]
  ds_read_b64_tr_b16 v[86:87], v6 offset:12800
  v_mfma_f32_16x16x32_bf16 v[148:151], v[48:51], v[88:91], v[148:151]
  s_add_u32 m0, s22, 77696
  s_nop 0
  buffer_load_dwordx4 v8, s[44:47], s21 offen offset:128 nt lds
  v_mfma_f32_16x16x32_bf16 v[144:147], v[44:47], v[88:91], v[144:147]
  s_waitcnt lgkmcnt(6)
  v_mfma_f32_16x16x32_bf16 v[160:163], v[92:95], v[44:47], v[160:163]
  ds_read_b64_tr_b16 v[88:89], v5 offset:16384
  v_mfma_f32_16x16x32_bf16 v[164:167], v[92:95], v[48:51], v[164:167]
  ds_read_b64_tr_b16 v[90:91], v5 offset:16896
  v_mfma_f32_16x16x32_bf16 v[168:171], v[92:95], v[52:55], v[168:171]
  s_add_u32 m0, s22, 81920
  s_nop 0
  buffer_load_dwordx4 v8, s[12:15], s21 offen offset:0 nt lds
  s_add_u32 s20, s20, 229376
  s_add_u32 s21, s21, 196608
  v_mfma_f32_16x16x32_bf16 v[172:175], v[92:95], v[56:59], v[172:175]
  s_waitcnt lgkmcnt(6)
  v_mfma_f32_16x16x32_bf16 v[188:191], v[76:79], v[56:59], v[188:191]
  ds_read_b64_tr_b16 v[92:93], v6 offset:16384
  v_mfma_f32_16x16x32_bf16 v[184:187], v[76:79], v[52:55], v[184:187]
  ds_read_b64_tr_b16 v[94:95], v6 offset:16896
  v_mfma_f32_16x16x32_bf16 v[180:183], v[76:79], v[48:51], v[180:183]
  v_mfma_f32_16x16x32_bf16 v[176:179], v[76:79], v[44:47], v[176:179]
  s_waitcnt vmcnt(6) lgkmcnt(6)
  s_barrier
  v_mfma_f32_16x16x32_bf16 v[192:195], v[44:47], v[80:83], v[192:195]
  ds_read_b64_tr_b16 v[76:77], v5 offset:20480
  v_mfma_f32_16x16x32_bf16 v[196:199], v[48:51], v[80:83], v[196:199]
  ds_read_b64_tr_b16 v[78:79], v5 offset:20992
  v_mfma_f32_16x16x32_bf16 v[200:203], v[52:55], v[80:83], v[200:203]
  ds_read_b128 v[60:63], v2 offset:49152
  v_mfma_f32_16x16x32_bf16 v[204:207], v[56:59], v[80:83], v[204:207]
  ds_read_b128 v[64:67], v2 offset:50176
  s_waitcnt lgkmcnt(8)
  v_mfma_f32_16x16x32_bf16 v[220:223], v[56:59], v[84:87], v[220:223]
  ds_read_b64_tr_b16 v[80:81], v6 offset:20480
  v_mfma_f32_16x16x32_bf16 v[216:219], v[52:55], v[84:87], v[216:219]
  ds_read_b64_tr_b16 v[82:83], v6 offset:20992
  v_mfma_f32_16x16x32_bf16 v[212:215], v[48:51], v[84:87], v[212:215]
  ds_read_b128 v[68:71], v2 offset:51200
  v_mfma_f32_16x16x32_bf16 v[208:211], v[44:47], v[84:87], v[208:211]
  ds_read_b128 v[72:75], v2 offset:52224
  s_waitcnt lgkmcnt(10)
  v_mfma_f32_16x16x32_bf16 v[224:227], v[88:91], v[44:47], v[224:227]
  ds_read_b64_tr_b16 v[84:85], v5 offset:24576
  v_mfma_f32_16x16x32_bf16 v[228:231], v[88:91], v[48:51], v[228:231]
  ds_read_b64_tr_b16 v[86:87], v5 offset:25088
  v_mfma_f32_16x16x32_bf16 v[232:235], v[88:91], v[52:55], v[232:235]
  v_mfma_f32_16x16x32_bf16 v[236:239], v[88:91], v[56:59], v[236:239]
  s_waitcnt lgkmcnt(10)
  v_mfma_f32_16x16x32_bf16 v[252:255], v[92:95], v[56:59], v[252:255]
  ds_read_b64_tr_b16 v[88:89], v6 offset:24576
  v_mfma_f32_16x16x32_bf16 v[248:251], v[92:95], v[52:55], v[248:251]
  ds_read_b64_tr_b16 v[90:91], v6 offset:25088
  v_mfma_f32_16x16x32_bf16 v[244:247], v[92:95], v[48:51], v[244:247]
  v_mfma_f32_16x16x32_bf16 v[240:243], v[92:95], v[44:47], v[240:243]
  s_waitcnt lgkmcnt(4)
  v_mfma_f32_16x16x32_bf16 v[96:99], v[76:79], v[60:63], v[96:99]
  ds_read_b64_tr_b16 v[92:93], v5 offset:28672
  v_mfma_f32_16x16x32_bf16 v[100:103], v[76:79], v[64:67], v[100:103]
  ds_read_b64_tr_b16 v[94:95], v5 offset:29184
  v_mfma_f32_16x16x32_bf16 v[104:107], v[76:79], v[68:71], v[104:107]
  s_add_u32 m0, s22, 86016
  s_nop 0
  buffer_load_dwordx4 v7, s[4:7], s20 offen offset:0 nt lds
  v_mfma_f32_16x16x32_bf16 v[108:111], v[76:79], v[72:75], v[108:111]
  v_mfma_f32_16x16x32_bf16 v[124:127], v[80:83], v[72:75], v[124:127]
  ds_read_b64_tr_b16 v[76:77], v6 offset:28672
  v_mfma_f32_16x16x32_bf16 v[120:123], v[80:83], v[68:71], v[120:123]
  ds_read_b64_tr_b16 v[78:79], v6 offset:29184
  v_mfma_f32_16x16x32_bf16 v[116:119], v[80:83], v[64:67], v[116:119]
  s_add_u32 m0, s22, 90112
  s_nop 0
  buffer_load_dwordx4 v8, s[44:47], s21 offen offset:0 nt lds
  v_mfma_f32_16x16x32_bf16 v[112:115], v[80:83], v[60:63], v[112:115]
  s_waitcnt lgkmcnt(6)
  v_mfma_f32_16x16x32_bf16 v[128:131], v[60:63], v[84:87], v[128:131]
  ds_read_b64_tr_b16 v[80:81], v5 offset:32768
  v_mfma_f32_16x16x32_bf16 v[132:135], v[64:67], v[84:87], v[132:135]
  ds_read_b64_tr_b16 v[82:83], v5 offset:33280
  v_mfma_f32_16x16x32_bf16 v[136:139], v[68:71], v[84:87], v[136:139]
  s_add_u32 m0, s22, 94208
  s_nop 0
  buffer_load_dwordx4 v7, s[8:11], s20 offen offset:0 nt lds
  v_mfma_f32_16x16x32_bf16 v[140:143], v[72:75], v[84:87], v[140:143]
  s_waitcnt lgkmcnt(6)
  v_mfma_f32_16x16x32_bf16 v[156:159], v[72:75], v[88:91], v[156:159]
  ds_read_b64_tr_b16 v[84:85], v6 offset:32768
  v_mfma_f32_16x16x32_bf16 v[152:155], v[68:71], v[88:91], v[152:155]
  ds_read_b64_tr_b16 v[86:87], v6 offset:33280
  v_mfma_f32_16x16x32_bf16 v[148:151], v[64:67], v[88:91], v[148:151]
  s_add_u32 m0, s22, 98176
  s_nop 0
  buffer_load_dwordx4 v8, s[44:47], s21 offen offset:128 nt lds
  v_mfma_f32_16x16x32_bf16 v[144:147], v[60:63], v[88:91], v[144:147]
  s_waitcnt lgkmcnt(6)
  v_mfma_f32_16x16x32_bf16 v[160:163], v[92:95], v[60:63], v[160:163]
  ds_read_b64_tr_b16 v[88:89], v5 offset:36864
  v_mfma_f32_16x16x32_bf16 v[164:167], v[92:95], v[64:67], v[164:167]
  ds_read_b64_tr_b16 v[90:91], v5 offset:37376
  v_mfma_f32_16x16x32_bf16 v[168:171], v[92:95], v[68:71], v[168:171]
  s_add_u32 m0, s22, 102400
  s_nop 0
  buffer_load_dwordx4 v8, s[12:15], s21 offen offset:0 nt lds
  s_add_u32 s20, s20, 229376
  s_add_u32 s21, s21, 196608
  v_mfma_f32_16x16x32_bf16 v[172:175], v[92:95], v[72:75], v[172:175]
  s_waitcnt lgkmcnt(6)
  v_mfma_f32_16x16x32_bf16 v[188:191], v[76:79], v[72:75], v[188:191]
  ds_read_b64_tr_b16 v[92:93], v6 offset:36864
  v_mfma_f32_16x16x32_bf16 v[184:187], v[76:79], v[68:71], v[184:187]
  ds_read_b64_tr_b16 v[94:95], v6 offset:37376
  v_mfma_f32_16x16x32_bf16 v[180:183], v[76:79], v[64:67], v[180:183]
  v_mfma_f32_16x16x32_bf16 v[176:179], v[76:79], v[60:63], v[176:179]
  s_waitcnt vmcnt(5) lgkmcnt(6)
  s_barrier
  v_mfma_f32_16x16x32_bf16 v[192:195], v[60:63], v[80:83], v[192:195]
  ds_read_b64_tr_b16 v[76:77], v3 offset:0
  v_mfma_f32_16x16x32_bf16 v[196:199], v[64:67], v[80:83], v[196:199]
  ds_read_b64_tr_b16 v[78:79], v3 offset:512
  v_mfma_f32_16x16x32_bf16 v[200:203], v[68:71], v[80:83], v[200:203]
  ds_read_b128 v[44:47], v2 offset:0
  v_mfma_f32_16x16x32_bf16 v[204:207], v[72:75], v[80:83], v[204:207]
  ds_read_b128 v[48:51], v2 offset:1024
  s_waitcnt lgkmcnt(8)
  v_mfma_f32_16x16x32_bf16 v[220:223], v[72:75], v[84:87], v[220:223]
  ds_read_b64_tr_b16 v[80:81], v4 offset:0
  v_mfma_f32_16x16x32_bf16 v[216:219], v[68:71], v[84:87], v[216:219]
  ds_read_b64_tr_b16 v[82:83], v4 offset:512
  v_mfma_f32_16x16x32_bf16 v[212:215], v[64:67], v[84:87], v[212:215]
  ds_read_b128 v[52:55], v2 offset:2048
  v_mfma_f32_16x16x32_bf16 v[208:211], v[60:63], v[84:87], v[208:211]
  ds_read_b128 v[56:59], v2 offset:3072
  s_waitcnt lgkmcnt(10)
  v_mfma_f32_16x16x32_bf16 v[224:227], v[88:91], v[60:63], v[224:227]
  ds_read_b64_tr_b16 v[84:85], v3 offset:4096
  v_mfma_f32_16x16x32_bf16 v[228:231], v[88:91], v[64:67], v[228:231]
  ds_read_b64_tr_b16 v[86:87], v3 offset:4608
  v_mfma_f32_16x16x32_bf16 v[232:235], v[88:91], v[68:71], v[232:235]
  v_mfma_f32_16x16x32_bf16 v[236:239], v[88:91], v[72:75], v[236:239]
  s_waitcnt lgkmcnt(10)
  v_mfma_f32_16x16x32_bf16 v[252:255], v[92:95], v[72:75], v[252:255]
  ds_read_b64_tr_b16 v[88:89], v4 offset:4096
  v_mfma_f32_16x16x32_bf16 v[248:251], v[92:95], v[68:71], v[248:251]
  ds_read_b64_tr_b16 v[90:91], v4 offset:4608
  v_mfma_f32_16x16x32_bf16 v[244:247], v[92:95], v[64:67], v[244:247]
  v_mfma_f32_16x16x32_bf16 v[240:243], v[92:95], v[60:63], v[240:243]
  s_sub_u32 s24, s24, 1
  s_cmp_lg_u32 s24, 0
  s_cbranch_scc1 k2_loop_Cw
mega_epi:
  s_lshl_b32 s38, s26, 3
  s_lshl_b32 s28, s29, 1
  s_add_u32 s38, s38, s28
  v_lshrrev_b32 v12, 4, v0
  v_lshlrev_b32 v12, 9, v12
  v_and_b32 v13, 15, v0
  v_lshl_add_u32 v10, v13, 4, v12
  v_and_b32 v13, 7, v0
  v_lshl_add_u32 v11, v13, 4, v12
  v_bfe_u32 v13, v0, 3, 1
  v_lshl_add_u32 v11, v13, 8, v11
  s_and_b32 s41, s38, 32
  s_bfe_u32 s28, s38, 0x40001
  s_add_u32 s41, s41, s28
  s_and_b32 s28, s97, 15
  s_lshl_b32 s28, s28, 1
  s_add_u32 s28, s28, s30
  s_lshl_b32 s28, s28, 6
  s_cmp_ge_u32 s97, 16
  s_cselect_b32 s32, s41, s38
  s_cselect_b32 s42, 12, 11
  s_cselect_b32 s43, 4194304, 0
  s_cselect_b32 s34, 1.0, 0x3e8293ee
  s_cselect_b32 s51, 7, 8
  s_cselect_b32 s33, 16, 11
  s_cselect_b64 vcc, -1, 0
  s_add_u32 s28, s28, s32
  s_lshl_b32 s33, 1, s33
  s_lshl_b32 s51, 1, s51
  s_lshl_b32 s28, s28, s42
  s_add_u32 s32, s43, s28
  s_add_u32 s42, s32, s33
  s_add_u32 s43, s42, s51
  s_add_u32 s33, s32, s51
  s_lshl_b32 s28, s23, 2
  s_add_u32 s28, s28, s30
  s_lshl_b32 s28, s28, 6
  s_add_u32 s28, s28, s41
  s_lshl_b32 s51, s28, 12
  v_cndmask_b32 v12, v10, v11, vcc
  s_lshr_b32 s39, s38, 2
  s_mul_i32 s39, s39, 112
  s_lshl_b32 s28, s96, 1
  s_add_u32 s39, s39, s28
  s_add_u32 s39, s39, s30
  s_lshl_b32 s39, s39, 13
  s_and_b32 s28, s29, 1
  s_lshl_b32 s28, s28, 12
  s_add_u32 s39, s39, s28
  s_lshl_b32 s40, s23, 5
  s_lshr_b32 s28, s2, 3
  s_add_u32 s40, s40, s28
  s_lshl_b32 s40, s40, 7
  s_lshl_b32 s60, s26, 5
  s_lshl_b32 s28, s23, 2
  s_add_u32 s60, s60, s28
  s_add_u32 s60, s60, s27
  s_lshl_b32 s60, s60, 7
  s_add_u32 s60, s60, 40960
  s_lshl_b32 s63, s23, 3
  s_add_u32 s63, s63, s26
  s_lshl_b32 s63, s63, 7
  s_add_u32 s63, s63, 32768
  s_cmp_eq_u32 s27, 3
  s_cselect_b32 s63, s63, 0x7f000000
  s_mov_b32 s48, 0xbdd2d3e8
  s_mov_b32 s49, 0xbdd2d3e8
  s_add_u32 s8, s36, 4194304
  s_addc_u32 s9, s37, 0
  s_mov_b32 s10, 12582912
  s_mov_b32 s11, 0x20000
  s_waitcnt vmcnt(0) lgkmcnt(0)
  s_nop 2
  v_mul_f32 v224, s34, v224
  v_mul_f32 v225, s34, v225
  v_mul_f32 v226, s34, v226
  v_mul_f32 v227, s34, v227
  v_mul_f32 v240, s34, v240
  v_mul_f32 v241, s34, v241
  v_mul_f32 v242, s34, v242
  v_mul_f32 v243, s34, v243
  v_cvt_pk_bf16_f32 v44, v224, v225
  v_cvt_pk_bf16_f32 v45, v226, v227
  v_cvt_pk_bf16_f32 v46, v240, v241
  v_cvt_pk_bf16_f32 v47, v242, v243
  buffer_store_dwordx4 v[44:47], v12, s[8:11], s32 offen sc1
  v_mul_f32 v228, s34, v228
  v_mul_f32 v229, s34, v229
  v_mul_f32 v230, s34, v230
  v_mul_f32 v231, s34, v231
  v_mul_f32 v244, s34, v244
  v_mul_f32 v245, s34, v245
  v_mul_f32 v246, s34, v246
  v_mul_f32 v247, s34, v247
  v_cvt_pk_bf16_f32 v48, v228, v229
  v_cvt_pk_bf16_f32 v49, v230, v231
  v_cvt_pk_bf16_f32 v50, v244, v245
  v_cvt_pk_bf16_f32 v51, v246, v247
  buffer_store_dwordx4 v[48:51], v12, s[8:11], s33 offen sc1
  v_mul_f32 v232, s34, v232
  v_mul_f32 v233, s34, v233
  v_mul_f32 v234, s34, v234
  v_mul_f32 v235, s34, v235
  v_mul_f32 v248, s34, v248
  v_mul_f32 v249, s34, v249
  v_mul_f32 v250, s34, v250
  v_mul_f32 v251, s34, v251
  v_cvt_pk_bf16_f32 v52, v232, v233
  v_cvt_pk_bf16_f32 v53, v234, v235
  v_cvt_pk_bf16_f32 v54, v248, v249
  v_cvt_pk_bf16_f32 v55, v250, v251
  v_mul_f32 v236, s34, v236
  v_mul_f32 v237, s34, v237
  v_mul_f32 v238, s34, v238
  v_mul_f32 v239, s34, v239
  v_mul_f32 v252, s34, v252
  v_mul_f32 v253, s34, v253
  v_mul_f32 v254, s34, v254
  v_mul_f32 v255, s34, v255
  v_cvt_pk_bf16_f32 v56, v236, v237
  v_cvt_pk_bf16_f32 v57, v238, v239
  v_cvt_pk_bf16_f32 v58, v252, v253
  v_cvt_pk_bf16_f32 v59, v254, v255
  s_cmp_eq_u32 s27, 3
  s_cbranch_scc1 mega_V
  buffer_store_dwordx4 v[52:55], v12, s[8:11], s42 offen sc1
  buffer_store_dwordx4 v[56:59], v12, s[8:11], s43 offen sc1
  s_branch mega_noV
mega_V:
  v_cvt_pk_bf16_f32 v60, v128, v129
  v_cvt_pk_bf16_f32 v61, v130, v131
  v_cvt_pk_bf16_f32 v62, v132, v133
  v_cvt_pk_bf16_f32 v63, v134, v135
  v_cvt_pk_bf16_f32 v64, v144, v145
  v_cvt_pk_bf16_f32 v65, v146, v147
  v_cvt_pk_bf16_f32 v66, v148, v149
  v_cvt_pk_bf16_f32 v67, v150, v151
  v_cvt_pk_bf16_f32 v68, v192, v193
  v_cvt_pk_bf16_f32 v69, v194, v195
  v_cvt_pk_bf16_f32 v70, v196, v197
  v_cvt_pk_bf16_f32 v71, v198, v199
  v_cvt_pk_bf16_f32 v72, v208, v209
  v_cvt_pk_bf16_f32 v73, v210, v211
  v_cvt_pk_bf16_f32 v74, v212, v213
  v_cvt_pk_bf16_f32 v75, v214, v215
  s_add_u32 s46, s51, 4196352
  buffer_store_dwordx4 v[60:63], v10, s[8:11], s46 offen sc1
  s_add_u32 s46, s51, 4196608
  buffer_store_dwordx4 v[64:67], v10, s[8:11], s46 offen sc1
  s_add_u32 s46, s51, 4720640
  buffer_store_dwordx4 v[68:71], v10, s[8:11], s46 offen sc1
  s_add_u32 s46, s51, 4720896
  buffer_store_dwordx4 v[72:75], v10, s[8:11], s46 offen sc1
  v_cvt_pk_bf16_f32 v76, v136, v137
  v_cvt_pk_bf16_f32 v77, v138, v139
  v_cvt_pk_bf16_f32 v78, v140, v141
  v_cvt_pk_bf16_f32 v79, v142, v143
  v_cvt_pk_bf16_f32 v80, v152, v153
  v_cvt_pk_bf16_f32 v81, v154, v155
  v_cvt_pk_bf16_f32 v82, v156, v157
  v_cvt_pk_bf16_f32 v83, v158, v159
  v_cvt_pk_bf16_f32 v84, v200, v201
  v_cvt_pk_bf16_f32 v85, v202, v203
  v_cvt_pk_bf16_f32 v86, v204, v205
  v_cvt_pk_bf16_f32 v87, v206, v207
  v_cvt_pk_bf16_f32 v88, v216, v217
  v_cvt_pk_bf16_f32 v89, v218, v219
  v_cvt_pk_bf16_f32 v90, v220, v221
  v_cvt_pk_bf16_f32 v91, v222, v223
mega_noV:
  s_barrier
  s_add_u32 s4, s36, 16777216
  s_addc_u32 s5, s37, 0
  s_mov_b32 s6, 14680064
  s_mov_b32 s7, 0x20000
  s_add_u32 s12, s36, 41943040
  s_addc_u32 s13, s37, 0
  s_mov_b32 s14, 270464
  s_mov_b32 s15, 0x20000
  v_mov_b32 v14, 0xc0135761
  v_mov_b32 v15, 0xc0135761
  s_cmp_lt_u32 s25, 4
  s_cselect_b32 s47, s39, 0x7f000000
  s_setprio 2
  s_cbranch_scc1 mega_fa_later
  s_setprio 3
  s_waitcnt vmcnt(0)
  v_mov_b32 v2, 163376
  v_mov_b32 v3, 1
  s_mov_b64 exec, 1
  ds_add_rtn_u32 v4, v2, v3
  s_waitcnt lgkmcnt(0)
  v_cmp_eq_u32 vcc, 7, v4
  s_cbranch_vccz fa1_nosig
  s_mov_b32 exec_lo, -1
  s_mov_b32 exec_hi, 0
  v_lshlrev_b32 v2, 2, v0
  v_mov_b32 v3, s3
  buffer_store_dword v3, v2, s[12:15], s40 offen sc1
  s_mov_b64 exec, -1
fa1_nosig:
  s_mov_b64 exec, -1
  s_setprio 1
mega_fa_later:
  v_pk_mul_f32 v[16:17], v[96:97], v[96:97]
  v_pk_mul_f32 v[18:19], v[98:99], v[98:99]
  v_pk_mul_f32 v[20:21], v[112:113], v[112:113]
  v_pk_mul_f32 v[22:23], v[114:115], v[114:115]
  v_pk_fma_f32 v[16:17], v[16:17], s[48:49], v[14:15]
  v_pk_fma_f32 v[18:19], v[18:19], s[48:49], v[14:15]
  v_pk_fma_f32 v[20:21], v[20:21], s[48:49], v[14:15]
  v_pk_fma_f32 v[22:23], v[22:23], s[48:49], v[14:15]
  v_pk_mul_f32 v[16:17], v[16:17], v[96:97]
  v_pk_mul_f32 v[18:19], v[18:19], v[98:99]
  v_pk_mul_f32 v[20:21], v[20:21], v[112:113]
  v_pk_mul_f32 v[22:23], v[22:23], v[114:115]
  v_exp_f32 v16, v16
  v_exp_f32 v17, v17
  v_exp_f32 v18, v18
  v_exp_f32 v19, v19
  v_exp_f32 v20, v20
  v_exp_f32 v21, v21
  v_exp_f32 v22, v22
  v_exp_f32 v23, v23
  v_pk_mul_f32 v[96:97], v[96:97], v[160:161]
  v_pk_mul_f32 v[98:99], v[98:99], v[162:163]
  v_pk_mul_f32 v[112:113], v[112:113], v[176:177]
  v_pk_mul_f32 v[114:115], v[114:115], v[178:179]
  v_pk_add_f32 v[16:17], v[16:17], 1.0 op_sel_hi:[1,0]
  v_pk_add_f32 v[18:19], v[18:19], 1.0 op_sel_hi:[1,0]
  v_pk_add_f32 v[20:21], v[20:21], 1.0 op_sel_hi:[1,0]
  v_pk_add_f32 v[22:23], v[22:23], 1.0 op_sel_hi:[1,0]
  v_rcp_f32 v16, v16
  v_rcp_f32 v17, v17
  v_rcp_f32 v18, v18
  v_rcp_f32 v19, v19
  v_rcp_f32 v20, v20
  v_rcp_f32 v21, v21
  v_rcp_f32 v22, v22
  v_rcp_f32 v23, v23
  s_nop 0
  v_pk_mul_f32 v[96:97], v[96:97], v[16:17]
  v_pk_mul_f32 v[98:99], v[98:99], v[18:19]
  v_pk_mul_f32 v[112:113], v[112:113], v[20:21]
  v_pk_mul_f32 v[114:115], v[114:115], v[22:23]
  v_cvt_pk_bf16_f32 v224, v96, v97
  v_cvt_pk_bf16_f32 v225, v98, v99
  v_cvt_pk_bf16_f32 v226, v112, v113
  v_cvt_pk_bf16_f32 v227, v114, v115
  v_pk_mul_f32 v[16:17], v[100:101], v[100:101]
  v_pk_mul_f32 v[18:19], v[102:103], v[102:103]
  v_pk_mul_f32 v[20:21], v[116:117], v[116:117]
  v_pk_mul_f32 v[22:23], v[118:119], v[118:119]
  v_pk_fma_f32 v[16:17], v[16:17], s[48:49], v[14:15]
  v_pk_fma_f32 v[18:19], v[18:19], s[48:49], v[14:15]
  v_pk_fma_f32 v[20:21], v[20:21], s[48:49], v[14:15]
  v_pk_fma_f32 v[22:23], v[22:23], s[48:49], v[14:15]
  v_pk_mul_f32 v[16:17], v[16:17], v[100:101]
  v_pk_mul_f32 v[18:19], v[18:19], v[102:103]
  v_pk_mul_f32 v[20:21], v[20:21], v[116:117]
  v_pk_mul_f32 v[22:23], v[22:23], v[118:119]
  v_exp_f32 v16, v16
  v_exp_f32 v17, v17
  v_exp_f32 v18, v18
  v_exp_f32 v19, v19
  v_exp_f32 v20, v20
  v_exp_f32 v21, v21
  v_exp_f32 v22, v22
  v_exp_f32 v23, v23
  v_pk_mul_f32 v[100:101], v[100:101], v[164:165]
  v_pk_mul_f32 v[102:103], v[102:103], v[166:167]
  v_pk_mul_f32 v[116:117], v[116:117], v[180:181]
  v_pk_mul_f32 v[118:119], v[118:119], v[182:183]
  v_pk_add_f32 v[16:17], v[16:17], 1.0 op_sel_hi:[1,0]
  v_pk_add_f32 v[18:19], v[18:19], 1.0 op_sel_hi:[1,0]
  v_pk_add_f32 v[20:21], v[20:21], 1.0 op_sel_hi:[1,0]
  v_pk_add_f32 v[22:23], v[22:23], 1.0 op_sel_hi:[1,0]
  v_rcp_f32 v16, v16
  v_rcp_f32 v17, v17
  v_rcp_f32 v18, v18
  v_rcp_f32 v19, v19
  v_rcp_f32 v20, v20
  v_rcp_f32 v21, v21
  v_rcp_f32 v22, v22
  v_rcp_f32 v23, v23
  s_nop 0
  v_pk_mul_f32 v[100:101], v[100:101], v[16:17]
  v_pk_mul_f32 v[102:103], v[102:103], v[18:19]
  v_pk_mul_f32 v[116:117], v[116:117], v[20:21]
  v_pk_mul_f32 v[118:119], v[118:119], v[22:23]
  v_cvt_pk_bf16_f32 v228, v100, v101
  v_cvt_pk_bf16_f32 v229, v102, v103
  v_cvt_pk_bf16_f32 v230, v116, v117
  v_cvt_pk_bf16_f32 v231, v118, v119
  v_pk_mul_f32 v[16:17], v[104:105], v[104:105]
  v_pk_mul_f32 v[18:19], v[106:107], v[106:107]
  v_pk_mul_f32 v[20:21], v[120:121], v[120:121]
  v_pk_mul_f32 v[22:23], v[122:123], v[122:123]
  v_pk_fma_f32 v[16:17], v[16:17], s[48:49], v[14:15]
  v_pk_fma_f32 v[18:19], v[18:19], s[48:49], v[14:15]
  v_pk_fma_f32 v[20:21], v[20:21], s[48:49], v[14:15]
  v_pk_fma_f32 v[22:23], v[22:23], s[48:49], v[14:15]
  v_pk_mul_f32 v[16:17], v[16:17], v[104:105]
  v_pk_mul_f32 v[18:19], v[18:19], v[106:107]
  v_pk_mul_f32 v[20:21], v[20:21], v[120:121]
  v_pk_mul_f32 v[22:23], v[22:23], v[122:123]
  v_exp_f32 v16, v16
  v_exp_f32 v17, v17
  v_exp_f32 v18, v18
  v_exp_f32 v19, v19
  v_exp_f32 v20, v20
  v_exp_f32 v21, v21
  v_exp_f32 v22, v22
  v_exp_f32 v23, v23
  v_pk_mul_f32 v[104:105], v[104:105], v[168:169]
  v_pk_mul_f32 v[106:107], v[106:107], v[170:171]
  v_pk_mul_f32 v[120:121], v[120:121], v[184:185]
  v_pk_mul_f32 v[122:123], v[122:123], v[186:187]
  v_pk_add_f32 v[16:17], v[16:17], 1.0 op_sel_hi:[1,0]
  v_pk_add_f32 v[18:19], v[18:19], 1.0 op_sel_hi:[1,0]
  v_pk_add_f32 v[20:21], v[20:21], 1.0 op_sel_hi:[1,0]
  v_pk_add_f32 v[22:23], v[22:23], 1.0 op_sel_hi:[1,0]
  v_rcp_f32 v16, v16
  v_rcp_f32 v17, v17
  v_rcp_f32 v18, v18
  v_rcp_f32 v19, v19
  v_rcp_f32 v20, v20
  v_rcp_f32 v21, v21
  v_rcp_f32 v22, v22
  v_rcp_f32 v23, v23
  s_nop 0
  v_pk_mul_f32 v[104:105], v[104:105], v[16:17]
  v_pk_mul_f32 v[106:107], v[106:107], v[18:19]
  v_pk_mul_f32 v[120:121], v[120:121], v[20:21]
  v_pk_mul_f32 v[122:123], v[122:123], v[22:23]
  v_cvt_pk_bf16_f32 v232, v104, v105
  v_cvt_pk_bf16_f32 v233, v106, v107
  v_cvt_pk_bf16_f32 v234, v120, v121
  v_cvt_pk_bf16_f32 v235, v122, v123
  v_pk_mul_f32 v[16:17], v[108:109], v[108:109]
  v_pk_mul_f32 v[18:19], v[110:111], v[110:111]
  v_pk_mul_f32 v[20:21], v[124:125], v[124:125]
  v_pk_mul_f32 v[22:23], v[126:127], v[126:127]
  v_pk_fma_f32 v[16:17], v[16:17], s[48:49], v[14:15]
  v_pk_fma_f32 v[18:19], v[18:19], s[48:49], v[14:15]
  v_pk_fma_f32 v[20:21], v[20:21], s[48:49], v[14:15]
  v_pk_fma_f32 v[22:23], v[22:23], s[48:49], v[14:15]
  v_pk_mul_f32 v[16:17], v[16:17], v[108:109]
  v_pk_mul_f32 v[18:19], v[18:19], v[110:111]
  v_pk_mul_f32 v[20:21], v[20:21], v[124:125]
  v_pk_mul_f32 v[22:23], v[22:23], v[126:127]
  v_exp_f32 v16, v16
  v_exp_f32 v17, v17
  v_exp_f32 v18, v18
  v_exp_f32 v19, v19
  v_exp_f32 v20, v20
  v_exp_f32 v21, v21
  v_exp_f32 v22, v22
  v_exp_f32 v23, v23
  v_pk_mul_f32 v[108:109], v[108:109], v[172:173]
  v_pk_mul_f32 v[110:111], v[110:111], v[174:175]
  v_pk_mul_f32 v[124:125], v[124:125], v[188:189]
  v_pk_mul_f32 v[126:127], v[126:127], v[190:191]
  v_pk_add_f32 v[16:17], v[16:17], 1.0 op_sel_hi:[1,0]
  v_pk_add_f32 v[18:19], v[18:19], 1.0 op_sel_hi:[1,0]
  v_pk_add_f32 v[20:21], v[20:21], 1.0 op_sel_hi:[1,0]
  v_pk_add_f32 v[22:23], v[22:23], 1.0 op_sel_hi:[1,0]
  v_rcp_f32 v16, v16
  v_rcp_f32 v17, v17
  v_rcp_f32 v18, v18
  v_rcp_f32 v19, v19
  v_rcp_f32 v20, v20
  v_rcp_f32 v21, v21
  v_rcp_f32 v22, v22
  v_rcp_f32 v23, v23
  s_nop 0
  v_pk_mul_f32 v[108:109], v[108:109], v[16:17]
  v_pk_mul_f32 v[110:111], v[110:111], v[18:19]
  v_pk_mul_f32 v[124:125], v[124:125], v[20:21]
  v_pk_mul_f32 v[126:127], v[126:127], v[22:23]
  v_cvt_pk_bf16_f32 v236, v108, v109
  v_cvt_pk_bf16_f32 v237, v110, v111
  v_cvt_pk_bf16_f32 v238, v124, v125
  v_cvt_pk_bf16_f32 v239, v126, v127
  s_cmp_ge_u32 s25, 4
  s_cbranch_scc1 mega_fa_done
  s_waitcnt vmcnt(0)
  v_mov_b32 v2, 163376
  v_mov_b32 v3, 1
  s_mov_b64 exec, 1
  ds_add_rtn_u32 v4, v2, v3
  s_waitcnt lgkmcnt(0)
  v_cmp_eq_u32 vcc, 7, v4
  s_cbranch_vccz fa2_nosig
  s_mov_b32 exec_lo, -1
  s_mov_b32 exec_hi, 0
  v_lshlrev_b32 v2, 2, v0
  v_mov_b32 v3, s3
  buffer_store_dword v3, v2, s[12:15], s40 offen sc1
  s_mov_b64 exec, -1
fa2_nosig:
  s_mov_b64 exec, -1
  buffer_store_dwordx4 v[224:227], v9, s[4:7], s39 offen offset:0 sc1
  buffer_store_dwordx4 v[228:231], v9, s[4:7], s39 offen offset:1024 sc1
  buffer_store_dwordx4 v[232:235], v9, s[4:7], s39 offen offset:2048 sc1
  buffer_store_dwordx4 v[236:239], v9, s[4:7], s39 offen offset:3072 sc1
mega_fa_done:
  s_cmp_eq_u32 s27, 3
  s_cbranch_scc1 mega_gelu_done
  v_pk_mul_f32 v[16:17], v[128:129], v[128:129]
  v_pk_mul_f32 v[18:19], v[130:131], v[130:131]
  v_pk_mul_f32 v[20:21], v[144:145], v[144:145]
  v_pk_mul_f32 v[22:23], v[146:147], v[146:147]
  v_pk_fma_f32 v[16:17], v[16:17], s[48:49], v[14:15]
  v_pk_fma_f32 v[18:19], v[18:19], s[48:49], v[14:15]
  v_pk_fma_f32 v[20:21], v[20:21], s[48:49], v[14:15]
  v_pk_fma_f32 v[22:23], v[22:23], s[48:49], v[14:15]
  v_pk_mul_f32 v[16:17], v[16:17], v[128:129]
  v_pk_mul_f32 v[18:19], v[18:19], v[130:131]
  v_pk_mul_f32 v[20:21], v[20:21], v[144:145]
  v_pk_mul_f32 v[22:23], v[22:23], v[146:147]
  v_exp_f32 v16, v16
  v_exp_f32 v17, v17
  v_exp_f32 v18, v18
  v_exp_f32 v19, v19
  v_exp_f32 v20, v20
  v_exp_f32 v21, v21
  v_exp_f32 v22, v22
  v_exp_f32 v23, v23
  v_pk_mul_f32 v[128:129], v[128:129], v[192:193]
  v_pk_mul_f32 v[130:131], v[130:131], v[194:195]
  v_pk_mul_f32 v[144:145], v[144:145], v[208:209]
  v_pk_mul_f32 v[146:147], v[146:147], v[210:211]
  v_pk_add_f32 v[16:17], v[16:17], 1.0 op_sel_hi:[1,0]
  v_pk_add_f32 v[18:19], v[18:19], 1.0 op_sel_hi:[1,0]
  v_pk_add_f32 v[20:21], v[20:21], 1.0 op_sel_hi:[1,0]
  v_pk_add_f32 v[22:23], v[22:23], 1.0 op_sel_hi:[1,0]
  v_rcp_f32 v16, v16
  v_rcp_f32 v17, v17
  v_rcp_f32 v18, v18
  v_rcp_f32 v19, v19
  v_rcp_f32 v20, v20
  v_rcp_f32 v21, v21
  v_rcp_f32 v22, v22
  v_rcp_f32 v23, v23
  s_nop 0
  v_pk_mul_f32 v[128:129], v[128:129], v[16:17]
  v_pk_mul_f32 v[130:131], v[130:131], v[18:19]
  v_pk_mul_f32 v[144:145], v[144:145], v[20:21]
  v_pk_mul_f32 v[146:147], v[146:147], v[22:23]
  v_cvt_pk_bf16_f32 v240, v128, v129
  v_cvt_pk_bf16_f32 v241, v130, v131
  v_cvt_pk_bf16_f32 v242, v144, v145
  v_cvt_pk_bf16_f32 v243, v146, v147
  s_add_u32 s47, s47, 16384
  buffer_store_dwordx4 v[240:243], v9, s[4:7], s47 offen offset:0 sc1
  v_pk_mul_f32 v[16:17], v[132:133], v[132:133]
  v_pk_mul_f32 v[18:19], v[134:135], v[134:135]
  v_pk_mul_f32 v[20:21], v[148:149], v[148:149]
  v_pk_mul_f32 v[22:23], v[150:151], v[150:151]
  v_pk_fma_f32 v[16:17], v[16:17], s[48:49], v[14:15]
  v_pk_fma_f32 v[18:19], v[18:19], s[48:49], v[14:15]
  v_pk_fma_f32 v[20:21], v[20:21], s[48:49], v[14:15]
  v_pk_fma_f32 v[22:23], v[22:23], s[48:49], v[14:15]
  v_pk_mul_f32 v[16:17], v[16:17], v[132:133]
  v_pk_mul_f32 v[18:19], v[18:19], v[134:135]
  v_pk_mul_f32 v[20:21], v[20:21], v[148:149]
  v_pk_mul_f32 v[22:23], v[22:23], v[150:151]
  v_exp_f32 v16, v16
  v_exp_f32 v17, v17
  v_exp_f32 v18, v18
  v_exp_f32 v19, v19
  v_exp_f32 v20, v20
  v_exp_f32 v21, v21
  v_exp_f32 v22, v22
  v_exp_f32 v23, v23
  v_pk_mul_f32 v[132:133], v[132:133], v[196:197]
  v_pk_mul_f32 v[134:135], v[134:135], v[198:199]
  v_pk_mul_f32 v[148:149], v[148:149], v[212:213]
  v_pk_mul_f32 v[150:151], v[150:151], v[214:215]
  v_pk_add_f32 v[16:17], v[16:17], 1.0 op_sel_hi:[1,0]
  v_pk_add_f32 v[18:19], v[18:19], 1.0 op_sel_hi:[1,0]
  v_pk_add_f32 v[20:21], v[20:21], 1.0 op_sel_hi:[1,0]
  v_pk_add_f32 v[22:23], v[22:23], 1.0 op_sel_hi:[1,0]
  v_rcp_f32 v16, v16
  v_rcp_f32 v17, v17
  v_rcp_f32 v18, v18
  v_rcp_f32 v19, v19
  v_rcp_f32 v20, v20
  v_rcp_f32 v21, v21
  v_rcp_f32 v22, v22
  v_rcp_f32 v23, v23
  s_nop 0
  v_pk_mul_f32 v[132:133], v[132:133], v[16:17]
  v_pk_mul_f32 v[134:135], v[134:135], v[18:19]
  v_pk_mul_f32 v[148:149], v[148:149], v[20:21]
  v_pk_mul_f32 v[150:151], v[150:151], v[22:23]
  v_cvt_pk_bf16_f32 v244, v132, v133
  v_cvt_pk_bf16_f32 v245, v134, v135
  v_cvt_pk_bf16_f32 v246, v148, v149
  v_cvt_pk_bf16_f32 v247, v150, v151
  buffer_store_dwordx4 v[244:247], v9, s[4:7], s47 offen offset:1024 sc1
  v_pk_mul_f32 v[16:17], v[136:137], v[136:137]
  v_pk_mul_f32 v[18:19], v[138:139], v[138:139]
  v_pk_mul_f32 v[20:21], v[152:153], v[152:153]
  v_pk_mul_f32 v[22:23], v[154:155], v[154:155]
  v_pk_fma_f32 v[16:17], v[16:17], s[48:49], v[14:15]
  v_pk_fma_f32 v[18:19], v[18:19], s[48:49], v[14:15]
  v_pk_fma_f32 v[20:21], v[20:21], s[48:49], v[14:15]
  v_pk_fma_f32 v[22:23], v[22:23], s[48:49], v[14:15]
  v_pk_mul_f32 v[16:17], v[16:17], v[136:137]
  v_pk_mul_f32 v[18:19], v[18:19], v[138:139]
  v_pk_mul_f32 v[20:21], v[20:21], v[152:153]
  v_pk_mul_f32 v[22:23], v[22:23], v[154:155]
  v_exp_f32 v16, v16
  v_exp_f32 v17, v17
  v_exp_f32 v18, v18
  v_exp_f32 v19, v19
  v_exp_f32 v20, v20
  v_exp_f32 v21, v21
  v_exp_f32 v22, v22
  v_exp_f32 v23, v23
  v_pk_mul_f32 v[136:137], v[136:137], v[200:201]
  v_pk_mul_f32 v[138:139], v[138:139], v[202:203]
  v_pk_mul_f32 v[152:153], v[152:153], v[216:217]
  v_pk_mul_f32 v[154:155], v[154:155], v[218:219]
  v_pk_add_f32 v[16:17], v[16:17], 1.0 op_sel_hi:[1,0]
  v_pk_add_f32 v[18:19], v[18:19], 1.0 op_sel_hi:[1,0]
  v_pk_add_f32 v[20:21], v[20:21], 1.0 op_sel_hi:[1,0]
  v_pk_add_f32 v[22:23], v[22:23], 1.0 op_sel_hi:[1,0]
  v_rcp_f32 v16, v16
  v_rcp_f32 v17, v17
  v_rcp_f32 v18, v18
  v_rcp_f32 v19, v19
  v_rcp_f32 v20, v20
  v_rcp_f32 v21, v21
  v_rcp_f32 v22, v22
  v_rcp_f32 v23, v23
  s_nop 0
  v_pk_mul_f32 v[136:137], v[136:137], v[16:17]
  v_pk_mul_f32 v[138:139], v[138:139], v[18:19]
  v_pk_mul_f32 v[152:153], v[152:153], v[20:21]
  v_pk_mul_f32 v[154:155], v[154:155], v[22:23]
  v_cvt_pk_bf16_f32 v248, v136, v137
  v_cvt_pk_bf16_f32 v249, v138, v139
  v_cvt_pk_bf16_f32 v250, v152, v153
  v_cvt_pk_bf16_f32 v251, v154, v155
  buffer_store_dwordx4 v[248:251], v9, s[4:7], s47 offen offset:2048 sc1
  v_pk_mul_f32 v[16:17], v[140:141], v[140:141]
  v_pk_mul_f32 v[18:19], v[142:143], v[142:143]
  v_pk_mul_f32 v[20:21], v[156:157], v[156:157]
  v_pk_mul_f32 v[22:23], v[158:159], v[158:159]
  v_pk_fma_f32 v[16:17], v[16:17], s[48:49], v[14:15]
  v_pk_fma_f32 v[18:19], v[18:19], s[48:49], v[14:15]
  v_pk_fma_f32 v[20:21], v[20:21], s[48:49], v[14:15]
  v_pk_fma_f32 v[22:23], v[22:23], s[48:49], v[14:15]
  v_pk_mul_f32 v[16:17], v[16:17], v[140:141]
  v_pk_mul_f32 v[18:19], v[18:19], v[142:143]
  v_pk_mul_f32 v[20:21], v[20:21], v[156:157]
  v_pk_mul_f32 v[22:23], v[22:23], v[158:159]
  v_exp_f32 v16, v16
  v_exp_f32 v17, v17
  v_exp_f32 v18, v18
  v_exp_f32 v19, v19
  v_exp_f32 v20, v20
  v_exp_f32 v21, v21
  v_exp_f32 v22, v22
  v_exp_f32 v23, v23
  v_pk_mul_f32 v[140:141], v[140:141], v[204:205]
  v_pk_mul_f32 v[142:143], v[142:143], v[206:207]
  v_pk_mul_f32 v[156:157], v[156:157], v[220:221]
  v_pk_mul_f32 v[158:159], v[158:159], v[222:223]
  v_pk_add_f32 v[16:17], v[16:17], 1.0 op_sel_hi:[1,0]
  v_pk_add_f32 v[18:19], v[18:19], 1.0 op_sel_hi:[1,0]
  v_pk_add_f32 v[20:21], v[20:21], 1.0 op_sel_hi:[1,0]
  v_pk_add_f32 v[22:23], v[22:23], 1.0 op_sel_hi:[1,0]
  v_rcp_f32 v16, v16
  v_rcp_f32 v17, v17
  v_rcp_f32 v18, v18
  v_rcp_f32 v19, v19
  v_rcp_f32 v20, v20
  v_rcp_f32 v21, v21
  v_rcp_f32 v22, v22
  v_rcp_f32 v23, v23
  s_nop 0
  v_pk_mul_f32 v[140:141], v[140:141], v[16:17]
  v_pk_mul_f32 v[142:143], v[142:143], v[18:19]
  v_pk_mul_f32 v[156:157], v[156:157], v[20:21]
  v_pk_mul_f32 v[158:159], v[158:159], v[22:23]
  v_cvt_pk_bf16_f32 v252, v140, v141
  v_cvt_pk_bf16_f32 v253, v142, v143
  v_cvt_pk_bf16_f32 v254, v156, v157
  v_cvt_pk_bf16_f32 v255, v158, v159
  buffer_store_dwordx4 v[252:255], v9, s[4:7], s47 offen offset:3072 sc1
mega_gelu_done:
  v_mov_b32 v1, v9
  s_mul_i32 s28, s29, 10240
  s_add_u32 s28, s28, 65536
  v_add_u32 v2, s28, v1
  s_cmp_ge_u32 s25, 4
  s_cbranch_scc1 mega_down
  s_cmp_lg_u32 s27, 3
  s_cbranch_scc1 mega_hoD
  buffer_store_dwordx4 v[52:55], v12, s[8:11], s42 offen sc1
  buffer_store_dwordx4 v[56:59], v12, s[8:11], s43 offen sc1
  s_add_u32 s46, s51, 4261888
  buffer_store_dwordx4 v[76:79], v10, s[8:11], s46 offen sc1
  s_add_u32 s46, s51, 4262144
  buffer_store_dwordx4 v[80:83], v10, s[8:11], s46 offen sc1
  s_add_u32 s46, s51, 4786176
  buffer_store_dwordx4 v[84:87], v10, s[8:11], s46 offen sc1
  s_add_u32 s46, s51, 4786432
  buffer_store_dwordx4 v[88:91], v10, s[8:11], s46 offen sc1
mega_hoD:
  s_load_dwordx2 s[16:17], s[0:1], 16
  s_load_dwordx2 s[40:41], s[0:1], 0
  s_load_dwordx2 s[44:45], s[0:1], 56
  s_bfe_u32 s48, s2, 0x20001
  s_lshl_b32 s48, s48, 2
  s_bfe_u32 s30, s2, 0x20003
  s_add_u32 s48, s48, s30
  s_and_b32 s49, s2, 1
  s_lshl_b32 s49, s49, 3
  s_lshr_b32 s30, s2, 5
  s_add_u32 s49, s49, s30
  v_and_b32 v105, 7, v0
  v_bfe_u32 v106, v0, 4, 1
  v_lshlrev_b32 v106, 2, v106
  v_xor_b32 v105, v105, v106
  v_lshlrev_b32 v105, 4, v105
  v_lshrrev_b32 v106, 3, v0
  v_lshl_add_u32 v104, v106, 11, v105
  s_lshl_b32 s61, s25, 14
  s_lshl_b32 s62, s25, 10
  s_add_u32 s62, s62, 65536
  s_add_u32 s61, s61, 917504
  s_add_u32 s62, s62, 57344
  s_and_b32 s28, s25, 1
  s_lshr_b32 s29, s25, 1
  s_and_b32 s26, s2, 7
  s_lshl_b32 s26, s26, 2
  s_lshr_b32 s30, s2, 6
  s_add_u32 s26, s26, s30
  s_bfe_u32 s27, s2, 0x30003
  s_lshl_b32 s30, s26, 18
  s_add_u32 s30, s30, 8388608
  s_add_u32 s31, s29, 1
  s_lshl_b32 s31, s31, 17
  s_lshl_b32 s20, s29, 17
  s_lshl_b32 s22, s26, 6
  s_lshl_b32 s23, s27, 3
  s_add_u32 s22, s22, s23
  s_lshl_b32 s23, s28, 2
  s_add_u32 s22, s22, s23
  s_lshl_b32 s22, s22, 11
  s_add_u32 s23, s22, 4096
  s_waitcnt lgkmcnt(0)
  s_add_u32 s4, s36, s30
  s_addc_u32 s5, s37, 0
  s_mov_b32 s6, s31
  s_mov_b32 s7, 0x20000
  s_add_u32 s8, s36, 4194304
  s_addc_u32 s9, s37, 0
  s_mov_b32 s10, 12582912
  s_mov_b32 s11, 0x20000
  s_add_u32 s12, s36, 41943040
  s_addc_u32 s13, s37, 0
  s_mov_b32 s14, 270464
  s_mov_b32 s15, 0x20000
  s_lshl_b32 s30, s49, 7
  s_sub_u32 s31, 2097152, s30
  s_add_u32 s16, s16, s30
  s_addc_u32 s17, s17, 0
  s_mov_b32 s18, s31
  s_mov_b32 s19, 0x20000
  s_lshl_b32 s30, s49, 17
  s_add_u32 s30, s30, 62914560
  s_add_u32 s16, s36, s30
  s_addc_u32 s17, s37, 0
  s_mov_b32 s18, 131072
  s_mov_b32 s19, 0x20000
  s_lshl_b32 s61, s25, 10
  s_add_u32 s61, s61, 57344
  s_mov_b32 s24, s20
  s_and_b32 s30, s2, 7
  s_lshl_b32 s30, s30, 12
  v_mov_b32 v217, 163384
  s_cmp_lg_u32 s25, 0
  s_cbranch_scc1 att_dep_follow
  v_and_b32 v218, 31, v0
  v_lshlrev_b32 v218, 7, v218
  s_mov_b32 s31, 1048576
att_dep_poll:
  buffer_load_dword v216, v218, s[12:15], s30 offen sc1
  s_waitcnt vmcnt(0)
att_dep_chk:
  v_cmp_ne_u32 vcc, s3, v216
  s_cbranch_vccz att_dep_ok
  s_mov_b64 exec, vcc
  s_sleep 2
  s_sub_u32 s31, s31, 1
  s_cmp_lg_u32 s31, 0
  s_cbranch_scc1 att_dep_poll
att_dep_ok:
  s_mov_b64 exec, -1
  v_mov_b32 v216, 1
  ds_write_b32 v217, v216
  s_branch att_dep_go
att_dep_follow:
  s_mov_b32 s31, 8388608
att_depf_poll:
  ds_read_b32 v216, v217 offset:0
  s_waitcnt lgkmcnt(0)
  v_cmp_ne_u32 vcc, 1, v216
  s_cbranch_vccz att_depf_ok
  s_sleep 1
  s_sub_u32 s31, s31, 1
  s_cmp_lg_u32 s31, 0
  s_cbranch_scc1 att_depf_poll
att_depf_ok:
att_dep_go:
  buffer_load_dwordx4 v[152:155], v1, s[4:7], s20 offen offset:0
  buffer_load_dwordx4 v[156:159], v1, s[4:7], s20 offen offset:1024
  buffer_load_dwordx4 v[160:163], v1, s[4:7], s20 offen offset:2048
  buffer_load_dwordx4 v[164:167], v1, s[4:7], s20 offen offset:3072
  s_add_u32 s20, s20, 4096
  buffer_load_dwordx4 v[8:11], v1, s[8:11], s22 offen offset:0
  buffer_load_dwordx4 v[12:15], v1, s[8:11], s22 offen offset:1024
  buffer_load_dwordx4 v[16:19], v1, s[8:11], s22 offen offset:2048
  buffer_load_dwordx4 v[20:23], v1, s[8:11], s22 offen offset:3072
  buffer_load_dwordx4 v[24:27], v1, s[8:11], s23 offen offset:0
  buffer_load_dwordx4 v[28:31], v1, s[8:11], s23 offen offset:1024
  buffer_load_dwordx4 v[32:35], v1, s[8:11], s23 offen offset:2048
  buffer_load_dwordx4 v[36:39], v1, s[8:11], s23 offen offset:3072
  buffer_load_dwordx4 v[168:171], v1, s[4:7], s20 offen offset:0
  buffer_load_dwordx4 v[172:175], v1, s[4:7], s20 offen offset:1024
  buffer_load_dwordx4 v[176:179], v1, s[4:7], s20 offen offset:2048
  buffer_load_dwordx4 v[180:183], v1, s[4:7], s20 offen offset:3072
  s_add_u32 s20, s20, 4096
  buffer_load_dwordx4 v[184:187], v1, s[4:7], s20 offen offset:0
  buffer_load_dwordx4 v[188:191], v1, s[4:7], s20 offen offset:1024
  buffer_load_dwordx4 v[192:195], v1, s[4:7], s20 offen offset:2048
  buffer_load_dwordx4 v[196:199], v1, s[4:7], s20 offen offset:3072
  s_add_u32 s20, s20, 4096
  s_lshl_b32 s30, s25, 2
  s_add_u32 s30, s30, 163392
  v_mov_b32 v2, s30
  v_mov_b32 v3, 1
  ds_write_b32 v2, v3
  v_mov_b64 v[40:41], 0
  v_mov_b64 v[42:43], 0
  v_mov_b64 v[44:45], 0
  v_mov_b64 v[46:47], 0
  v_mov_b64 v[48:49], 0
  v_mov_b64 v[50:51], 0
  v_mov_b64 v[52:53], 0
  v_mov_b64 v[54:55], 0
  v_mov_b64 v[56:57], 0
  v_mov_b64 v[58:59], 0
  v_mov_b64 v[60:61], 0
  v_mov_b64 v[62:63], 0
  v_mov_b64 v[64:65], 0
  v_mov_b64 v[66:67], 0
  v_mov_b64 v[68:69], 0
  v_mov_b64 v[70:71], 0
  v_mov_b64 v[72:73], 0
  v_mov_b64 v[74:75], 0
  v_mov_b64 v[76:77], 0
  v_mov_b64 v[78:79], 0
  v_mov_b64 v[80:81], 0
  v_mov_b64 v[82:83], 0
  v_mov_b64 v[84:85], 0
  v_mov_b64 v[86:87], 0
  v_mov_b64 v[88:89], 0
  v_mov_b64 v[90:91], 0
  v_mov_b64 v[92:93], 0
  v_mov_b64 v[94:95], 0
  v_mov_b64 v[96:97], 0
  v_mov_b64 v[98:99], 0
  v_mov_b64 v[100:101], 0
  v_mov_b64 v[102:103], 0
  v_mov_b64 v[148:149], 0
  v_mov_b64 v[150:151], 0
  v_mov_b64 v[212:213], 0
  v_mov_b64 v[214:215], 0
  v_mov_b64 v[208:209], 0
  v_mov_b64 v[210:211], 0
  v_and_b32 v2, 6, v0
  v_mov_b32 v3, 0x3f803f80
  v_cmp_eq_u32 vcc, 0, v2
  v_cmp_eq_u32 s[30:31], 4, v2
  v_and_b32 v2, 1, v0
  v_cndmask_b32 v4, 0, v3, vcc
  v_cndmask_b32 v6, 0, v3, s[30:31]
  v_cmp_eq_u32 vcc, 0, v2
  v_mov_b32 v5, v4
  v_mov_b32 v7, v6
  v_mov_b32 v2, 0xeeee
  v_mov_b32 v3, 0x4444
  v_cndmask_b32 v111, v2, v3, vcc
  v_mov_b64 v[144:145], 0
  v_mov_b64 v[146:147], 0
  v_mov_b64 v[240:241], 0
  v_mov_b64 v[242:243], 0
  v_mov_b64 v[244:245], 0
  v_mov_b64 v[246:247], 0
  v_mov_b64 v[248:249], 0
  v_mov_b64 v[250:251], 0
  v_mov_b64 v[252:253], 0
  v_mov_b64 v[254:255], 0
  s_mov_b32 s21, 8
  s_and_b32 s33, s2, 7
  s_lshl_b32 s33, s33, 10
  s_add_u32 s33, s33, 32768
  v_and_b32 v217, 7, v0
  v_lshlrev_b32 v217, 7, v217
  s_waitcnt vmcnt(8)
  v_mov_b32 v218, 163380
  v_mov_b32 v219, 1
  s_mov_b64 exec, 1
  ds_add_rtn_u32 v220, v218, v219
  s_waitcnt lgkmcnt(0)
  v_cmp_eq_u32 vcc, 7, v220
  s_cbranch_vccz fha_nosig
  s_mov_b32 exec_lo, -1
  s_mov_b32 exec_hi, 0
  v_lshlrev_b32 v218, 2, v0
  v_mov_b32 v219, s3
  buffer_store_dword v219, v218, s[12:15], s60 offen sc1
  buffer_store_dword v219, v218, s[12:15], s63 offen sc1
  s_mov_b64 exec, -1
fha_nosig:
  s_mov_b64 exec, -1
  s_setprio 0
  v_mfma_f32_32x32x16_bf16 v[112:127], v[152:155], v[8:11], 0
  v_mfma_f32_32x32x16_bf16 v[112:127], v[156:159], v[12:15], v[112:127]
  s_nop 11
.p2align 6
att_loop:
  s_bitcmp1_b32 96, s21
  s_cbranch_scc1 att_chk2
att_chk2_ret:
  v_mfma_f32_32x32x16_bf16 v[128:143], v[152:155], v[16:19], 0
  v_exp_f32 v112, v112
  v_exp_f32 v113, v113
  v_exp_f32 v114, v114
  v_exp_f32 v115, v115
  v_mfma_f32_32x32x16_bf16 v[88:103], v[212:215], v[148:151], v[88:103]
  v_exp_f32 v116, v116
  v_exp_f32 v117, v117
  v_exp_f32 v118, v118
  v_exp_f32 v119, v119
  v_smfmac_f32_16x16x64_bf16 v[252:255], v[4:7], v[144:151], v111
  v_cvt_pk_bf16_f32 v144, v112, v113
  v_cvt_pk_bf16_f32 v145, v114, v115
  v_cvt_pk_bf16_f32 v146, v116, v117
  v_cvt_pk_bf16_f32 v147, v118, v119
  v_mfma_f32_32x32x16_bf16 v[128:143], v[156:159], v[20:23], v[128:143]
  v_exp_f32 v120, v120
  v_exp_f32 v121, v121
  v_exp_f32 v122, v122
  v_exp_f32 v123, v123
  v_mfma_f32_32x32x16_bf16 v[40:55], v[160:163], v[144:147], v[40:55]
  v_exp_f32 v124, v124
  v_exp_f32 v125, v125
  v_exp_f32 v126, v126
  v_exp_f32 v127, v127
  v_cvt_pk_bf16_f32 v148, v120, v121
  v_cvt_pk_bf16_f32 v149, v122, v123
  v_cvt_pk_bf16_f32 v150, v124, v125
  v_cvt_pk_bf16_f32 v151, v126, v127
  v_mfma_f32_32x32x16_bf16 v[112:127], v[152:155], v[24:27], 0
  v_exp_f32 v128, v128
  v_exp_f32 v129, v129
  v_exp_f32 v130, v130
  v_exp_f32 v131, v131
  buffer_load_dwordx4 v[200:203], v1, s[4:7], s20 offen offset:0
  v_mfma_f32_32x32x16_bf16 v[40:55], v[164:167], v[148:151], v[40:55]
  v_exp_f32 v132, v132
  v_exp_f32 v133, v133
  v_exp_f32 v134, v134
  v_exp_f32 v135, v135
  v_smfmac_f32_16x16x64_bf16 v[240:243], v[4:7], v[144:151], v111
  v_cvt_pk_bf16_f32 v144, v128, v129
  v_cvt_pk_bf16_f32 v145, v130, v131
  v_cvt_pk_bf16_f32 v146, v132, v133
  v_cvt_pk_bf16_f32 v147, v134, v135
  v_mfma_f32_32x32x16_bf16 v[112:127], v[156:159], v[28:31], v[112:127]
  v_exp_f32 v136, v136
  v_exp_f32 v137, v137
  v_exp_f32 v138, v138
  v_exp_f32 v139, v139
  buffer_load_dwordx4 v[204:207], v1, s[4:7], s20 offen offset:1024
  v_mfma_f32_32x32x16_bf16 v[56:71], v[160:163], v[144:147], v[56:71]
  v_exp_f32 v140, v140
  v_exp_f32 v141, v141
  v_exp_f32 v142, v142
  v_exp_f32 v143, v143
  v_cvt_pk_bf16_f32 v148, v136, v137
  v_cvt_pk_bf16_f32 v149, v138, v139
  v_cvt_pk_bf16_f32 v150, v140, v141
  v_cvt_pk_bf16_f32 v151, v142, v143
  v_mfma_f32_32x32x16_bf16 v[128:143], v[152:155], v[32:35], 0
  v_exp_f32 v112, v112
  v_exp_f32 v113, v113
  v_exp_f32 v114, v114
  v_exp_f32 v115, v115
  buffer_load_dwordx4 v[208:211], v1, s[4:7], s20 offen offset:2048
  v_mfma_f32_32x32x16_bf16 v[56:71], v[164:167], v[148:151], v[56:71]
  v_exp_f32 v116, v116
  v_exp_f32 v117, v117
  v_exp_f32 v118, v118
  v_exp_f32 v119, v119
  v_smfmac_f32_16x16x64_bf16 v[244:247], v[4:7], v[144:151], v111
  v_cvt_pk_bf16_f32 v144, v112, v113
  v_cvt_pk_bf16_f32 v145, v114, v115
  v_cvt_pk_bf16_f32 v146, v116, v117
  v_cvt_pk_bf16_f32 v147, v118, v119
  v_mfma_f32_32x32x16_bf16 v[128:143], v[156:159], v[36:39], v[128:143]
  v_exp_f32 v120, v120
  v_exp_f32 v121, v121
  v_exp_f32 v122, v122
  v_exp_f32 v123, v123
  buffer_load_dwordx4 v[212:215], v1, s[4:7], s20 offen offset:3072
  s_add_u32 s20, s20, 4096
  v_mfma_f32_32x32x16_bf16 v[72:87], v[160:163], v[144:147], v[72:87]
  v_exp_f32 v124, v124
  v_exp_f32 v125, v125
  v_exp_f32 v126, v126
  v_exp_f32 v127, v127
  v_cvt_pk_bf16_f32 v148, v120, v121
  v_cvt_pk_bf16_f32 v149, v122, v123
  v_cvt_pk_bf16_f32 v150, v124, v125
  v_cvt_pk_bf16_f32 v151, v126, v127
  s_waitcnt vmcnt(8)
  v_mfma_f32_32x32x16_bf16 v[112:127], v[168:171], v[8:11], 0
  v_exp_f32 v128, v128
  v_exp_f32 v129, v129
  v_exp_f32 v130, v130
  v_exp_f32 v131, v131
  v_mfma_f32_32x32x16_bf16 v[72:87], v[164:167], v[148:151], v[72:87]
  v_exp_f32 v132, v132
  v_exp_f32 v133, v133
  v_exp_f32 v134, v134
  v_exp_f32 v135, v135
  v_smfmac_f32_16x16x64_bf16 v[248:251], v[4:7], v[144:151], v111
  v_cvt_pk_bf16_f32 v144, v128, v129
  v_cvt_pk_bf16_f32 v145, v130, v131
  v_cvt_pk_bf16_f32 v146, v132, v133
  v_cvt_pk_bf16_f32 v147, v134, v135
  v_mfma_f32_32x32x16_bf16 v[112:127], v[172:175], v[12:15], v[112:127]
  v_exp_f32 v136, v136
  v_exp_f32 v137, v137
  v_exp_f32 v138, v138
  v_exp_f32 v139, v139
  v_mfma_f32_32x32x16_bf16 v[88:103], v[160:163], v[144:147], v[88:103]
  v_exp_f32 v140, v140
  v_exp_f32 v141, v141
  v_exp_f32 v142, v142
  v_exp_f32 v143, v143
  v_cvt_pk_bf16_f32 v148, v136, v137
  v_cvt_pk_bf16_f32 v149, v138, v139
  v_cvt_pk_bf16_f32 v150, v140, v141
  v_cvt_pk_bf16_f32 v151, v142, v143
  v_mfma_f32_32x32x16_bf16 v[128:143], v[168:171], v[16:19], 0
  v_exp_f32 v112, v112
  v_exp_f32 v113, v113
  v_exp_f32 v114, v114
  v_exp_f32 v115, v115
  v_mfma_f32_32x32x16_bf16 v[88:103], v[164:167], v[148:151], v[88:103]
  v_exp_f32 v116, v116
  v_exp_f32 v117, v117
  v_exp_f32 v118, v118
  v_exp_f32 v119, v119
  v_smfmac_f32_16x16x64_bf16 v[252:255], v[4:7], v[144:151], v111
  v_cvt_pk_bf16_f32 v144, v112, v113
  v_cvt_pk_bf16_f32 v145, v114, v115
  v_cvt_pk_bf16_f32 v146, v116, v117
  v_cvt_pk_bf16_f32 v147, v118, v119
  v_mfma_f32_32x32x16_bf16 v[128:143], v[172:175], v[20:23], v[128:143]
  v_exp_f32 v120, v120
  v_exp_f32 v121, v121
  v_exp_f32 v122, v122
  v_exp_f32 v123, v123
  v_mfma_f32_32x32x16_bf16 v[40:55], v[176:179], v[144:147], v[40:55]
  v_exp_f32 v124, v124
  v_exp_f32 v125, v125
  v_exp_f32 v126, v126
  v_exp_f32 v127, v127
  v_cvt_pk_bf16_f32 v148, v120, v121
  v_cvt_pk_bf16_f32 v149, v122, v123
  v_cvt_pk_bf16_f32 v150, v124, v125
  v_cvt_pk_bf16_f32 v151, v126, v127
  v_mfma_f32_32x32x16_bf16 v[112:127], v[168:171], v[24:27], 0
  v_exp_f32 v128, v128
  v_exp_f32 v129, v129
  v_exp_f32 v130, v130
  v_exp_f32 v131, v131
  buffer_load_dwordx4 v[152:155], v1, s[4:7], s20 offen offset:0
  v_mfma_f32_32x32x16_bf16 v[40:55], v[180:183], v[148:151], v[40:55]
  v_exp_f32 v132, v132
  v_exp_f32 v133, v133
  v_exp_f32 v134, v134
  v_exp_f32 v135, v135
  v_smfmac_f32_16x16x64_bf16 v[240:243], v[4:7], v[144:151], v111
  v_cvt_pk_bf16_f32 v144, v128, v129
  v_cvt_pk_bf16_f32 v145, v130, v131
  v_cvt_pk_bf16_f32 v146, v132, v133
  v_cvt_pk_bf16_f32 v147, v134, v135
  v_mfma_f32_32x32x16_bf16 v[112:127], v[172:175], v[28:31], v[112:127]
  v_exp_f32 v136, v136
  v_exp_f32 v137, v137
  v_exp_f32 v138, v138
  v_exp_f32 v139, v139
  buffer_load_dwordx4 v[156:159], v1, s[4:7], s20 offen offset:1024
  v_mfma_f32_32x32x16_bf16 v[56:71], v[176:179], v[144:147], v[56:71]
  v_exp_f32 v140, v140
  v_exp_f32 v141, v141
  v_exp_f32 v142, v142
  v_exp_f32 v143, v143
  v_cvt_pk_bf16_f32 v148, v136, v137
  v_cvt_pk_bf16_f32 v149, v138, v139
  v_cvt_pk_bf16_f32 v150, v140, v141
  v_cvt_pk_bf16_f32 v151, v142, v143
  v_mfma_f32_32x32x16_bf16 v[128:143], v[168:171], v[32:35], 0
  v_exp_f32 v112, v112
  v_exp_f32 v113, v113
  v_exp_f32 v114, v114
  v_exp_f32 v115, v115
  buffer_load_dwordx4 v[160:163], v1, s[4:7], s20 offen offset:2048
  v_mfma_f32_32x32x16_bf16 v[56:71], v[180:183], v[148:151], v[56:71]
  v_exp_f32 v116, v116
  v_exp_f32 v117, v117
  v_exp_f32 v118, v118
  v_exp_f32 v119, v119
  v_smfmac_f32_16x16x64_bf16 v[244:247], v[4:7], v[144:151], v111
  v_cvt_pk_bf16_f32 v144, v112, v113
  v_cvt_pk_bf16_f32 v145, v114, v115
  v_cvt_pk_bf16_f32 v146, v116, v117
  v_cvt_pk_bf16_f32 v147, v118, v119
  v_mfma_f32_32x32x16_bf16 v[128:143], v[172:175], v[36:39], v[128:143]
  v_exp_f32 v120, v120
  v_exp_f32 v121, v121
  v_exp_f32 v122, v122
  v_exp_f32 v123, v123
  buffer_load_dwordx4 v[164:167], v1, s[4:7], s20 offen offset:3072
  s_add_u32 s20, s20, 4096
  v_mfma_f32_32x32x16_bf16 v[72:87], v[176:179], v[144:147], v[72:87]
  v_exp_f32 v124, v124
  v_exp_f32 v125, v125
  v_exp_f32 v126, v126
  v_exp_f32 v127, v127
  v_cvt_pk_bf16_f32 v148, v120, v121
  v_cvt_pk_bf16_f32 v149, v122, v123
  v_cvt_pk_bf16_f32 v150, v124, v125
  v_cvt_pk_bf16_f32 v151, v126, v127
  s_waitcnt vmcnt(8)
  v_mfma_f32_32x32x16_bf16 v[112:127], v[184:187], v[8:11], 0
  v_exp_f32 v128, v128
  v_exp_f32 v129, v129
  v_exp_f32 v130, v130
  v_exp_f32 v131, v131
  v_mfma_f32_32x32x16_bf16 v[72:87], v[180:183], v[148:151], v[72:87]
  v_exp_f32 v132, v132
  v_exp_f32 v133, v133
  v_exp_f32 v134, v134
  v_exp_f32 v135, v135
  v_smfmac_f32_16x16x64_bf16 v[248:251], v[4:7], v[144:151], v111
  v_cvt_pk_bf16_f32 v144, v128, v129
  v_cvt_pk_bf16_f32 v145, v130, v131
  v_cvt_pk_bf16_f32 v146, v132, v133
  v_cvt_pk_bf16_f32 v147, v134, v135
  v_mfma_f32_32x32x16_bf16 v[112:127], v[188:191], v[12:15], v[112:127]
  v_exp_f32 v136, v136
  v_exp_f32 v137, v137
  v_exp_f32 v138, v138
  v_exp_f32 v139, v139
  v_mfma_f32_32x32x16_bf16 v[88:103], v[176:179], v[144:147], v[88:103]
  v_exp_f32 v140, v140
  v_exp_f32 v141, v141
  v_exp_f32 v142, v142
  v_exp_f32 v143, v143
  v_cvt_pk_bf16_f32 v148, v136, v137
  v_cvt_pk_bf16_f32 v149, v138, v139
  v_cvt_pk_bf16_f32 v150, v140, v141
  v_cvt_pk_bf16_f32 v151, v142, v143
  v_mfma_f32_32x32x16_bf16 v[128:143], v[184:187], v[16:19], 0
  v_exp_f32 v112, v112
  v_exp_f32 v113, v113
  v_exp_f32 v114, v114
  v_exp_f32 v115, v115
  v_mfma_f32_32x32x16_bf16 v[88:103], v[180:183], v[148:151], v[88:103]
  v_exp_f32 v116, v116
  v_exp_f32 v117, v117
  v_exp_f32 v118, v118
  v_exp_f32 v119, v119
  v_smfmac_f32_16x16x64_bf16 v[252:255], v[4:7], v[144:151], v111
  v_cvt_pk_bf16_f32 v144, v112, v113
  v_cvt_pk_bf16_f32 v145, v114, v115
  v_cvt_pk_bf16_f32 v146, v116, v117
  v_cvt_pk_bf16_f32 v147, v118, v119
  v_mfma_f32_32x32x16_bf16 v[128:143], v[188:191], v[20:23], v[128:143]
  v_exp_f32 v120, v120
  v_exp_f32 v121, v121
  v_exp_f32 v122, v122
  v_exp_f32 v123, v123
  v_mfma_f32_32x32x16_bf16 v[40:55], v[192:195], v[144:147], v[40:55]
  v_exp_f32 v124, v124
  v_exp_f32 v125, v125
  v_exp_f32 v126, v126
  v_exp_f32 v127, v127
  v_cvt_pk_bf16_f32 v148, v120, v121
  v_cvt_pk_bf16_f32 v149, v122, v123
  v_cvt_pk_bf16_f32 v150, v124, v125
  v_cvt_pk_bf16_f32 v151, v126, v127
  v_mfma_f32_32x32x16_bf16 v[112:127], v[184:187], v[24:27], 0
  v_exp_f32 v128, v128
  v_exp_f32 v129, v129
  v_exp_f32 v130, v130
  v_exp_f32 v131, v131
  buffer_load_dwordx4 v[168:171], v1, s[4:7], s20 offen offset:0
  v_mfma_f32_32x32x16_bf16 v[40:55], v[196:199], v[148:151], v[40:55]
  v_exp_f32 v132, v132
  v_exp_f32 v133, v133
  v_exp_f32 v134, v134
  v_exp_f32 v135, v135
  v_smfmac_f32_16x16x64_bf16 v[240:243], v[4:7], v[144:151], v111
  v_cvt_pk_bf16_f32 v144, v128, v129
  v_cvt_pk_bf16_f32 v145, v130, v131
  v_cvt_pk_bf16_f32 v146, v132, v133
  v_cvt_pk_bf16_f32 v147, v134, v135
  v_mfma_f32_32x32x16_bf16 v[112:127], v[188:191], v[28:31], v[112:127]
  v_exp_f32 v136, v136
  v_exp_f32 v137, v137
  v_exp_f32 v138, v138
  v_exp_f32 v139, v139
  buffer_load_dwordx4 v[172:175], v1, s[4:7], s20 offen offset:1024
  v_mfma_f32_32x32x16_bf16 v[56:71], v[192:195], v[144:147], v[56:71]
  v_exp_f32 v140, v140
  v_exp_f32 v141, v141
  v_exp_f32 v142, v142
  v_exp_f32 v143, v143
  v_cvt_pk_bf16_f32 v148, v136, v137
  v_cvt_pk_bf16_f32 v149, v138, v139
  v_cvt_pk_bf16_f32 v150, v140, v141
  v_cvt_pk_bf16_f32 v151, v142, v143
  v_mfma_f32_32x32x16_bf16 v[128:143], v[184:187], v[32:35], 0
  v_exp_f32 v112, v112
  v_exp_f32 v113, v113
  v_exp_f32 v114, v114
  v_exp_f32 v115, v115
  buffer_load_dwordx4 v[176:179], v1, s[4:7], s20 offen offset:2048
  v_mfma_f32_32x32x16_bf16 v[56:71], v[196:199], v[148:151], v[56:71]
  v_exp_f32 v116, v116
  v_exp_f32 v117, v117
  v_exp_f32 v118, v118
  v_exp_f32 v119, v119
  v_smfmac_f32_16x16x64_bf16 v[244:247], v[4:7], v[144:151], v111
  v_cvt_pk_bf16_f32 v144, v112, v113
  v_cvt_pk_bf16_f32 v145, v114, v115
  v_cvt_pk_bf16_f32 v146, v116, v117
  v_cvt_pk_bf16_f32 v147, v118, v119
  v_mfma_f32_32x32x16_bf16 v[128:143], v[188:191], v[36:39], v[128:143]
  v_exp_f32 v120, v120
  v_exp_f32 v121, v121
  v_exp_f32 v122, v122
  v_exp_f32 v123, v123
  buffer_load_dwordx4 v[180:183], v1, s[4:7], s20 offen offset:3072
  s_add_u32 s20, s20, 4096
  v_mfma_f32_32x32x16_bf16 v[72:87], v[192:195], v[144:147], v[72:87]
  v_exp_f32 v124, v124
  v_exp_f32 v125, v125
  v_exp_f32 v126, v126
  v_exp_f32 v127, v127
  v_cvt_pk_bf16_f32 v148, v120, v121
  v_cvt_pk_bf16_f32 v149, v122, v123
  v_cvt_pk_bf16_f32 v150, v124, v125
  v_cvt_pk_bf16_f32 v151, v126, v127
  s_waitcnt vmcnt(8)
  v_mfma_f32_32x32x16_bf16 v[112:127], v[200:203], v[8:11], 0
  v_exp_f32 v128, v128
  v_exp_f32 v129, v129
  v_exp_f32 v130, v130
  v_exp_f32 v131, v131
  v_mfma_f32_32x32x16_bf16 v[72:87], v[196:199], v[148:151], v[72:87]
  v_exp_f32 v132, v132
  v_exp_f32 v133, v133
  v_exp_f32 v134, v134
  v_exp_f32 v135, v135
  v_smfmac_f32_16x16x64_bf16 v[248:251], v[4:7], v[144:151], v111
  v_cvt_pk_bf16_f32 v144, v128, v129
  v_cvt_pk_bf16_f32 v145, v130, v131
  v_cvt_pk_bf16_f32 v146, v132, v133
  v_cvt_pk_bf16_f32 v147, v134, v135
  v_mfma_f32_32x32x16_bf16 v[112:127], v[204:207], v[12:15], v[112:127]
  v_exp_f32 v136, v136
  v_exp_f32 v137, v137
  v_exp_f32 v138, v138
  v_exp_f32 v139, v139
  v_mfma_f32_32x32x16_bf16 v[88:103], v[192:195], v[144:147], v[88:103]
  v_exp_f32 v140, v140
  v_exp_f32 v141, v141
  v_exp_f32 v142, v142
  v_exp_f32 v143, v143
  v_cvt_pk_bf16_f32 v148, v136, v137
  v_cvt_pk_bf16_f32 v149, v138, v139
  v_cvt_pk_bf16_f32 v150, v140, v141
  v_cvt_pk_bf16_f32 v151, v142, v143
  v_mfma_f32_32x32x16_bf16 v[128:143], v[200:203], v[16:19], 0
  v_exp_f32 v112, v112
  v_exp_f32 v113, v113
  v_exp_f32 v114, v114
  v_exp_f32 v115, v115
  v_mfma_f32_32x32x16_bf16 v[88:103], v[196:199], v[148:151], v[88:103]
  v_exp_f32 v116, v116
  v_exp_f32 v117, v117
  v_exp_f32 v118, v118
  v_exp_f32 v119, v119
  v_smfmac_f32_16x16x64_bf16 v[252:255], v[4:7], v[144:151], v111
  v_cvt_pk_bf16_f32 v144, v112, v113
  v_cvt_pk_bf16_f32 v145, v114, v115
  v_cvt_pk_bf16_f32 v146, v116, v117
  v_cvt_pk_bf16_f32 v147, v118, v119
  v_mfma_f32_32x32x16_bf16 v[128:143], v[204:207], v[20:23], v[128:143]
  v_exp_f32 v120, v120
  v_exp_f32 v121, v121
  v_exp_f32 v122, v122
  v_exp_f32 v123, v123
  v_mfma_f32_32x32x16_bf16 v[40:55], v[208:211], v[144:147], v[40:55]
  v_exp_f32 v124, v124
  v_exp_f32 v125, v125
  v_exp_f32 v126, v126
  v_exp_f32 v127, v127
  v_cvt_pk_bf16_f32 v148, v120, v121
  v_cvt_pk_bf16_f32 v149, v122, v123
  v_cvt_pk_bf16_f32 v150, v124, v125
  v_cvt_pk_bf16_f32 v151, v126, v127
  v_mfma_f32_32x32x16_bf16 v[112:127], v[200:203], v[24:27], 0
  v_exp_f32 v128, v128
  v_exp_f32 v129, v129
  v_exp_f32 v130, v130
  v_exp_f32 v131, v131
  buffer_load_dwordx4 v[184:187], v1, s[4:7], s20 offen offset:0
  v_mfma_f32_32x32x16_bf16 v[40:55], v[212:215], v[148:151], v[40:55]
  v_exp_f32 v132, v132
  v_exp_f32 v133, v133
  v_exp_f32 v134, v134
  v_exp_f32 v135, v135
  v_smfmac_f32_16x16x64_bf16 v[240:243], v[4:7], v[144:151], v111
  v_cvt_pk_bf16_f32 v144, v128, v129
  v_cvt_pk_bf16_f32 v145, v130, v131
  v_cvt_pk_bf16_f32 v146, v132, v133
  v_cvt_pk_bf16_f32 v147, v134, v135
  v_mfma_f32_32x32x16_bf16 v[112:127], v[204:207], v[28:31], v[112:127]
  v_exp_f32 v136, v136
  v_exp_f32 v137, v137
  v_exp_f32 v138, v138
  v_exp_f32 v139, v139
  buffer_load_dwordx4 v[188:191], v1, s[4:7], s20 offen offset:1024
  v_mfma_f32_32x32x16_bf16 v[56:71], v[208:211], v[144:147], v[56:71]
  v_exp_f32 v140, v140
  v_exp_f32 v141, v141
  v_exp_f32 v142, v142
  v_exp_f32 v143, v143
  v_cvt_pk_bf16_f32 v148, v136, v137
  v_cvt_pk_bf16_f32 v149, v138, v139
  v_cvt_pk_bf16_f32 v150, v140, v141
  v_cvt_pk_bf16_f32 v151, v142, v143
  v_mfma_f32_32x32x16_bf16 v[128:143], v[200:203], v[32:35], 0
  v_exp_f32 v112, v112
  v_exp_f32 v113, v113
  v_exp_f32 v114, v114
  v_exp_f32 v115, v115
  buffer_load_dwordx4 v[192:195], v1, s[4:7], s20 offen offset:2048
  v_mfma_f32_32x32x16_bf16 v[56:71], v[212:215], v[148:151], v[56:71]
  v_exp_f32 v116, v116
  v_exp_f32 v117, v117
  v_exp_f32 v118, v118
  v_exp_f32 v119, v119
  v_smfmac_f32_16x16x64_bf16 v[244:247], v[4:7], v[144:151], v111
  v_cvt_pk_bf16_f32 v144, v112, v113
  v_cvt_pk_bf16_f32 v145, v114, v115
  v_cvt_pk_bf16_f32 v146, v116, v117
  v_cvt_pk_bf16_f32 v147, v118, v119
  v_mfma_f32_32x32x16_bf16 v[128:143], v[204:207], v[36:39], v[128:143]
  v_exp_f32 v120, v120
  v_exp_f32 v121, v121
  v_exp_f32 v122, v122
  v_exp_f32 v123, v123
  buffer_load_dwordx4 v[196:199], v1, s[4:7], s20 offen offset:3072
  s_add_u32 s20, s20, 4096
  v_mfma_f32_32x32x16_bf16 v[72:87], v[208:211], v[144:147], v[72:87]
  v_exp_f32 v124, v124
  v_exp_f32 v125, v125
  v_exp_f32 v126, v126
  v_exp_f32 v127, v127
  v_cvt_pk_bf16_f32 v148, v120, v121
  v_cvt_pk_bf16_f32 v149, v122, v123
  v_cvt_pk_bf16_f32 v150, v124, v125
  v_cvt_pk_bf16_f32 v151, v126, v127
  s_waitcnt vmcnt(8)
  v_mfma_f32_32x32x16_bf16 v[112:127], v[152:155], v[8:11], 0
  v_exp_f32 v128, v128
  v_exp_f32 v129, v129
  v_exp_f32 v130, v130
  v_exp_f32 v131, v131
  v_mfma_f32_32x32x16_bf16 v[72:87], v[212:215], v[148:151], v[72:87]
  v_exp_f32 v132, v132
  v_exp_f32 v133, v133
  v_exp_f32 v134, v134
  v_exp_f32 v135, v135
  v_smfmac_f32_16x16x64_bf16 v[248:251], v[4:7], v[144:151], v111
  v_cvt_pk_bf16_f32 v144, v128, v129
  v_cvt_pk_bf16_f32 v145, v130, v131
  v_cvt_pk_bf16_f32 v146, v132, v133
  v_cvt_pk_bf16_f32 v147, v134, v135
  v_mfma_f32_32x32x16_bf16 v[112:127], v[156:159], v[12:15], v[112:127]
  v_exp_f32 v136, v136
  v_exp_f32 v137, v137
  v_exp_f32 v138, v138
  v_exp_f32 v139, v139
  v_mfma_f32_32x32x16_bf16 v[88:103], v[208:211], v[144:147], v[88:103]
  v_exp_f32 v140, v140
  v_exp_f32 v141, v141
  v_exp_f32 v142, v142
  v_exp_f32 v143, v143
  s_sub_u32 s21, s21, 1
  s_cmp_lg_u32 s21, 0
  v_cvt_pk_bf16_f32 v148, v136, v137
  v_cvt_pk_bf16_f32 v149, v138, v139
  v_cvt_pk_bf16_f32 v150, v140, v141
  v_cvt_pk_bf16_f32 v151, v142, v143
  s_cbranch_scc1 att_loop
  s_setprio 3
  v_mfma_f32_32x32x16_bf16 v[88:103], v[212:215], v[148:151], v[88:103]
  v_smfmac_f32_16x16x64_bf16 v[252:255], v[4:7], v[144:151], v111
  v_mov_b32 v220, 0
  v_mov_b32 v221, 0
  v_mov_b32 v222, 0
  v_mov_b32 v223, 0
  v_mul_f32 v232, abs(v40), abs(v41)
  v_mul_f32 v233, abs(v42), abs(v43)
  v_mul_f32 v234, abs(v44), abs(v45)
  v_mul_f32 v235, abs(v46), abs(v47)
  v_fma_f32 v232, abs(v48), abs(v49), v232
  v_fma_f32 v233, abs(v50), abs(v51), v233
  v_fma_f32 v234, abs(v52), abs(v53), v234
  v_fma_f32 v235, abs(v54), abs(v55), v235
  v_fma_f32 v232, abs(v56), abs(v57), v232
  v_fma_f32 v233, abs(v58), abs(v59), v233
  v_fma_f32 v234, abs(v60), abs(v61), v234
  v_fma_f32 v235, abs(v62), abs(v63), v235
  v_fma_f32 v232, abs(v64), abs(v65), v232
  v_fma_f32 v233, abs(v66), abs(v67), v233
  v_fma_f32 v234, abs(v68), abs(v69), v234
  v_fma_f32 v235, abs(v70), abs(v71), v235
  v_fma_f32 v232, abs(v72), abs(v73), v232
  v_fma_f32 v233, abs(v74), abs(v75), v233
  v_fma_f32 v234, abs(v76), abs(v77), v234
  v_fma_f32 v235, abs(v78), abs(v79), v235
  v_fma_f32 v232, abs(v80), abs(v81), v232
  v_fma_f32 v233, abs(v82), abs(v83), v233
  v_fma_f32 v234, abs(v84), abs(v85), v234
  v_fma_f32 v235, abs(v86), abs(v87), v235
  v_fma_f32 v232, abs(v88), abs(v89), v232
  v_fma_f32 v233, abs(v90), abs(v91), v233
  v_fma_f32 v234, abs(v92), abs(v93), v234
  v_fma_f32 v235, abs(v94), abs(v95), v235
  v_fma_f32 v232, abs(v96), abs(v97), v232
  v_fma_f32 v233, abs(v98), abs(v99), v233
  v_fma_f32 v234, abs(v100), abs(v101), v234
  v_fma_f32 v235, abs(v102), abs(v103), v235
  v_add_f32 v216, v240, v241
  v_add_f32 v217, v244, v245
  v_add_f32 v218, v248, v249
  v_add_f32 v219, v252, v253
  v_add_f32 v232, v232, v233
  v_add_f32 v234, v234, v235
  v_add_f32 v224, v232, v234
  v_mul_f32 v224, 0, v224
  v_min3_f32 v226, v216, v217, v218
  v_min_f32 v226, v226, v219
  v_add_f32 v227, v216, v217
  v_add_f32 v228, v218, v219
  v_add_f32 v227, v227, v228
  v_add_f32 v227, v227, v224
  s_mov_b32 s30, 0x1f800000
  s_mov_b32 s31, 0x71800000
  v_cmp_nle_f32 vcc, s30, v226
  v_cmp_nge_f32 s[32:33], s31, v227
  s_or_b64 vcc, vcc, s[32:33]
  s_cbranch_vccnz att_fallback
att_fin:
  s_mul_i32 s30, s25, 9216
  s_add_u32 s30, s30, 126464
  s_xor_b32 s31, s25, 2
  s_lshl_b32 s33, s31, 2
  s_mul_i32 s31, s31, 9216
  s_add_u32 s31, s31, 126464
  v_add_u32 v2, s30, v1
  v_add_u32 v3, s31, v1
  s_cmp_eq_u32 s29, 0
  s_cbranch_scc1 att_send_hi
  v_mov_b32 v224, v216
  v_mov_b32 v225, v217
  v_mov_b32 v226, v220
  v_mov_b32 v227, v221
  ds_write_b128 v2, v[40:43] offset:0
  ds_write_b128 v2, v[44:47] offset:1024
  ds_write_b128 v2, v[48:51] offset:2048
  ds_write_b128 v2, v[52:55] offset:3072
  ds_write_b128 v2, v[56:59] offset:4096
  ds_write_b128 v2, v[60:63] offset:5120
  ds_write_b128 v2, v[64:67] offset:6144
  ds_write_b128 v2, v[68:71] offset:7168
  ds_write_b128 v2, v[224:227] offset:8192
  v_mov_b64 v[216:217], v[218:219]
  v_mov_b64 v[220:221], v[222:223]
  s_waitcnt lgkmcnt(0)
  v_mov_b64 v[40:41], v[72:73]
  v_mov_b64 v[42:43], v[74:75]
  v_mov_b64 v[44:45], v[76:77]
  v_mov_b64 v[46:47], v[78:79]
  v_mov_b64 v[48:49], v[80:81]
  v_mov_b64 v[50:51], v[82:83]
  v_mov_b64 v[52:53], v[84:85]
  v_mov_b64 v[54:55], v[86:87]
  v_mov_b64 v[56:57], v[88:89]
  v_mov_b64 v[58:59], v[90:91]
  v_mov_b64 v[60:61], v[92:93]
  v_mov_b64 v[62:63], v[94:95]
  v_mov_b64 v[64:65], v[96:97]
  v_mov_b64 v[66:67], v[98:99]
  v_mov_b64 v[68:69], v[100:101]
  v_mov_b64 v[70:71], v[102:103]
  s_branch att_sent
att_send_hi:
  v_mov_b32 v224, v218
  v_mov_b32 v225, v219
  v_mov_b32 v226, v222
  v_mov_b32 v227, v223
  ds_write_b128 v2, v[72:75] offset:0
  ds_write_b128 v2, v[76:79] offset:1024
  ds_write_b128 v2, v[80:83] offset:2048
  ds_write_b128 v2, v[84:87] offset:3072
  ds_write_b128 v2, v[88:91] offset:4096
  ds_write_b128 v2, v[92:95] offset:5120
  ds_write_b128 v2, v[96:99] offset:6144
  ds_write_b128 v2, v[100:103] offset:7168
  ds_write_b128 v2, v[224:227] offset:8192
  s_waitcnt lgkmcnt(0)
att_sent:
  s_lshl_b32 s32, s25, 2
  s_add_u32 s32, s32, 163328
  s_add_u32 s33, s33, 163328
  v_mov_b32 v4, s32
  v_mov_b32 v5, s33
  v_mov_b32 v6, 1
  ds_write_b32 v4, v6
  s_add_u32 s8, s36, 33554432
  s_addc_u32 s9, s37, 0
  s_mov_b32 s10, 4194304
  s_mov_b32 s11, 0x20000
  s_and_b32 s30, s26, 3
  s_lshr_b32 s31, s26, 3
  s_lshl_b32 s31, s31, 2
  s_add_u32 s30, s30, s31
  s_and_b32 s31, s26, 4
  s_lshl_b32 s31, s31, 2
  s_add_u32 s26, s30, s31
  s_lshl_b32 s30, s27, 3
  s_lshl_b32 s31, s28, 2
  s_add_u32 s30, s30, s31
  s_lshl_b32 s31, s29, 1
  s_add_u32 s30, s30, s31
  s_lshl_b32 s30, s30, 5
  s_add_u32 s30, s30, s26
  s_lshl_b32 s30, s30, 11
  s_add_u32 s31, s30, 65536
  s_mov_b32 s34, 8388608
att_x_poll:
  ds_read_b32 v8, v5 offset:0
  s_waitcnt lgkmcnt(0)
  v_cmp_ne_u32 vcc, 1, v8
  s_cbranch_vccz att_x_ok
  s_sleep 1
  s_sub_u32 s34, s34, 1
  s_cmp_lg_u32 s34, 0
  s_cbranch_scc1 att_x_poll
att_x_ok:
  ds_read_b128 v[224:227], v3 offset:8192
  ds_read_b128 v[72:75], v3 offset:0
  ds_read_b128 v[76:79], v3 offset:1024
  ds_read_b128 v[80:83], v3 offset:2048
  ds_read_b128 v[84:87], v3 offset:3072
  ds_read_b128 v[88:91], v3 offset:4096
  ds_read_b128 v[92:95], v3 offset:5120
  ds_read_b128 v[96:99], v3 offset:6144
  ds_read_b128 v[100:103], v3 offset:7168
  s_waitcnt lgkmcnt(8)
  v_max_f32 v232, v220, v226
  v_max_f32 v233, v221, v227
  v_sub_f32 v228, v220, v232
  v_sub_f32 v230, v226, v232
  v_sub_f32 v229, v221, v233
  v_sub_f32 v231, v227, v233
  v_exp_f32 v228, v228
  v_exp_f32 v230, v230
  v_exp_f32 v229, v229
  v_exp_f32 v231, v231
  s_nop 0
  v_mul_f32 v216, v216, v228
  v_fmac_f32 v216, v224, v230
  v_mul_f32 v217, v217, v229
  v_fmac_f32 v217, v225, v231
  v_rcp_f32 v216, v216
  v_rcp_f32 v217, v217
  s_nop 0
  v_mul_f32 v228, v228, v216
  v_mul_f32 v230, v230, v216
  v_mul_f32 v229, v229, v217
  v_mul_f32 v231, v231, v217
  v_mul_f32 v40, v40, v228
  v_mul_f32 v41, v41, v228
  v_mul_f32 v42, v42, v228
  v_mul_f32 v43, v43, v228
  v_mul_f32 v44, v44, v228
  v_mul_f32 v45, v45, v228
  v_mul_f32 v46, v46, v228
  v_mul_f32 v47, v47, v228
  v_mul_f32 v48, v48, v228
  v_mul_f32 v49, v49, v228
  v_mul_f32 v50, v50, v228
  v_mul_f32 v51, v51, v228
  v_mul_f32 v52, v52, v228
  v_mul_f32 v53, v53, v228
  v_mul_f32 v54, v54, v228
  v_mul_f32 v55, v55, v228
  v_mul_f32 v56, v56, v229
  v_mul_f32 v57, v57, v229
  v_mul_f32 v58, v58, v229
  v_mul_f32 v59, v59, v229
  v_mul_f32 v60, v60, v229
  v_mul_f32 v61, v61, v229
  v_mul_f32 v62, v62, v229
  v_mul_f32 v63, v63, v229
  v_mul_f32 v64, v64, v229
  v_mul_f32 v65, v65, v229
  v_mul_f32 v66, v66, v229
  v_mul_f32 v67, v67, v229
  v_mul_f32 v68, v68, v229
  v_mul_f32 v69, v69, v229
  v_mul_f32 v70, v70, v229
  v_mul_f32 v71, v71, v229
  s_waitcnt lgkmcnt(0)
  ds_write_b32 v4, v6 offset:96
  v_fmac_f32 v40, v72, v230
  v_fmac_f32 v41, v73, v230
  v_fmac_f32 v42, v74, v230
  v_fmac_f32 v43, v75, v230
  v_fmac_f32 v44, v76, v230
  v_fmac_f32 v45, v77, v230
  v_fmac_f32 v46, v78, v230
  v_fmac_f32 v47, v79, v230
  v_fmac_f32 v48, v80, v230
  v_fmac_f32 v49, v81, v230
  v_fmac_f32 v50, v82, v230
  v_fmac_f32 v51, v83, v230
  v_fmac_f32 v52, v84, v230
  v_fmac_f32 v53, v85, v230
  v_fmac_f32 v54, v86, v230
  v_fmac_f32 v55, v87, v230
  v_cvt_pk_bf16_f32 v112, v40, v41
  v_cvt_pk_bf16_f32 v113, v42, v43
  v_cvt_pk_bf16_f32 v114, v44, v45
  v_cvt_pk_bf16_f32 v115, v46, v47
  v_cvt_pk_bf16_f32 v116, v48, v49
  v_cvt_pk_bf16_f32 v117, v50, v51
  v_cvt_pk_bf16_f32 v118, v52, v53
  v_cvt_pk_bf16_f32 v119, v54, v55
  buffer_store_dwordx4 v[112:115], v1, s[8:11], s30 offen sc1
  buffer_store_dwordx4 v[116:119], v1, s[8:11], s30 offen offset:1024 sc1
  v_fmac_f32 v56, v88, v231
  v_fmac_f32 v57, v89, v231
  v_fmac_f32 v58, v90, v231
  v_fmac_f32 v59, v91, v231
  v_fmac_f32 v60, v92, v231
  v_fmac_f32 v61, v93, v231
  v_fmac_f32 v62, v94, v231
  v_fmac_f32 v63, v95, v231
  v_fmac_f32 v64, v96, v231
  v_fmac_f32 v65, v97, v231
  v_fmac_f32 v66, v98, v231
  v_fmac_f32 v67, v99, v231
  v_fmac_f32 v68, v100, v231
  v_fmac_f32 v69, v101, v231
  v_fmac_f32 v70, v102, v231
  v_fmac_f32 v71, v103, v231
  v_cvt_pk_bf16_f32 v120, v56, v57
  v_cvt_pk_bf16_f32 v121, v58, v59
  v_cvt_pk_bf16_f32 v122, v60, v61
  v_cvt_pk_bf16_f32 v123, v62, v63
  v_cvt_pk_bf16_f32 v124, v64, v65
  v_cvt_pk_bf16_f32 v125, v66, v67
  v_cvt_pk_bf16_f32 v126, v68, v69
  v_cvt_pk_bf16_f32 v127, v70, v71
  buffer_store_dwordx4 v[120:123], v1, s[8:11], s31 offen sc1
  buffer_store_dwordx4 v[124:127], v1, s[8:11], s31 offen offset:1024 sc1
  s_lshl_b32 s52, s48, 1
  s_add_u32 s52, s52, s29
  s_lshl_b32 s52, s52, 12
  s_add_u32 s52, s52, 73728
  s_add_u32 s53, s52, 2048
  v_and_b32 v109, 15, v0
  v_lshlrev_b32 v109, 7, v109
  buffer_load_dword v110, v109, s[12:15], s52 offen sc1
  s_lshl_b32 s30, s27, 1
  s_add_u32 s30, s30, s28
  s_lshl_b32 s30, s30, 1
  s_add_u32 s30, s30, s29
  s_lshl_b32 s30, s30, 5
  s_add_u32 s30, s30, s26
  s_lshl_b32 s30, s30, 7
  s_add_u32 s30, s30, 73728
  v_lshrrev_b32 v12, 5, v0
  v_bfe_u32 v13, v0, 2, 2
  v_lshl_add_u32 v12, v12, 2, v13
  v_lshlrev_b32 v12, 7, v12
  v_bfe_u32 v13, v0, 4, 1
  v_lshl_add_u32 v12, v13, 5, v12
  v_and_b32 v13, 1, v0
  v_lshl_add_u32 v12, v13, 4, v12
  v_bfe_u32 v13, v0, 1, 1
  v_lshl_add_u32 v12, v13, 3, v12
  v_bfe_u32 v13, v0, 3, 1
  v_lshl_add_u32 v12, v13, 6, v12
  v_add_u32 v8, 0x10000, v12
  v_xor_b32 v9, 64, v8
  v_add_u32 v10, 28672, v8
  v_add_u32 v11, 28672, v9
  v_mov_b64 v[64:65], 0
  v_mov_b64 v[66:67], 0
  v_mov_b64 v[68:69], 0
  v_mov_b64 v[70:71], 0
  v_mov_b64 v[72:73], 0
  v_mov_b64 v[74:75], 0
  v_mov_b64 v[76:77], 0
  v_mov_b64 v[78:79], 0
  v_mov_b64 v[80:81], 0
  v_mov_b64 v[82:83], 0
  v_mov_b64 v[84:85], 0
  v_mov_b64 v[86:87], 0
  v_mov_b64 v[88:89], 0
  v_mov_b64 v[90:91], 0
  v_mov_b64 v[92:93], 0
  v_mov_b64 v[94:95], 0
  s_mov_b32 s42, 4194304
  s_mov_b32 s43, 0x20000
  s_mov_b32 s46, 4194304
  s_mov_b32 s47, 0x20000
  v_and_b32 v12, 31, v0
  v_lshrrev_b32 v13, 5, v0
  v_lshlrev_b32 v3, 11, v12
  v_lshl_add_u32 v3, v13, 4, v3
  v_and_b32 v7, 15, v0
  v_lshlrev_b32 v7, 11, v7
  v_lshl_add_u32 v7, v13, 4, v7
  v_bfe_u32 v14, v0, 4, 1
  v_lshl_add_u32 v7, v14, 5, v7
  v_lshlrev_b32 v13, 1, v13
  v_and_b32 v14, 15, v0
  v_xor_b32 v13, v13, v14
  v_lshlrev_b32 v13, 4, v13
  v_lshl_add_u32 v15, v12, 8, v13
  s_lshl_b32 s38, s48, 2
  s_add_u32 s38, s38, s25
  s_lshl_b32 s38, s38, 16
  s_lshl_b32 s27, s49, 7
  s_add_u32 s50, s38, s27
  s_add_u32 s51, s50, 32768
  v_mov_b32 v5, 163328
  s_waitcnt vmcnt(0)
  s_mov_b32 exec_lo, -1
  s_mov_b32 exec_hi, 0
  v_lshlrev_b32 v2, 2, v0
  v_mov_b32 v96, s3
  buffer_store_dword v96, v2, s[12:15], s30 offen sc1
  s_mov_b64 exec, -1
  buffer_load_dwordx4 v[48:51], v3, s[40:43], s50 offen offset:0
  buffer_load_dwordx4 v[52:55], v3, s[40:43], s50 offen offset:32
  buffer_load_dwordx4 v[56:59], v3, s[40:43], s50 offen offset:64
  buffer_load_dwordx4 v[60:63], v3, s[40:43], s50 offen offset:96
  s_mov_b32 s34, 8388608
att_f2_poll:
  ds_read_b128 v[96:99], v5 offset:96
  s_waitcnt lgkmcnt(0)
  v_and_b32 v96, v96, v97
  v_and_b32 v98, v98, v99
  v_and_b32 v96, v96, v98
  v_cmp_ne_u32 vcc, 1, v96
  s_cbranch_vccz att_f2_ok
  s_sleep 1
  s_sub_u32 s34, s34, 1
  s_cmp_lg_u32 s34, 0
  s_cbranch_scc1 att_f2_poll
att_f2_ok:
  s_mov_b32 s34, 8388608
att_f1_poll:
  ds_read_b128 v[96:99], v5 offset:160
  s_waitcnt lgkmcnt(0)
  v_and_b32 v96, v96, v97
  v_and_b32 v98, v98, v99
  v_and_b32 v96, v96, v98
  v_cmp_ne_u32 vcc, 1, v96
  s_cbranch_vccz att_f1_ok
  s_sleep 1
  s_sub_u32 s34, s34, 1
  s_cmp_lg_u32 s34, 0
  s_cbranch_scc1 att_f1_poll
att_f1_ok:
  s_mov_b32 m0, s62
  s_add_u32 s62, s62, 4096
  buffer_load_dwordx4 v1, s[16:19], s61 offen sc1 lds
  s_add_u32 s61, s61, 4096
  s_mov_b32 m0, s62
  s_add_u32 s62, s62, 4096
  buffer_load_dwordx4 v1, s[16:19], s61 offen sc1 lds
  s_add_u32 s61, s61, 4096
  s_mov_b32 m0, s62
  s_add_u32 s62, s62, 4096
  buffer_load_dwordx4 v1, s[16:19], s61 offen sc1 lds
  s_add_u32 s61, s61, 4096
  s_mov_b32 m0, s62
  s_add_u32 s62, s62, 4096
  buffer_load_dwordx4 v1, s[16:19], s61 offen sc1 lds
  s_add_u32 s61, s61, 4096
  s_mov_b32 m0, s62
  s_add_u32 s62, s62, 4096
  buffer_load_dwordx4 v1, s[16:19], s61 offen sc1 lds
  s_add_u32 s61, s61, 4096
  s_mov_b32 m0, s62
  s_add_u32 s62, s62, 4096
  buffer_load_dwordx4 v1, s[16:19], s61 offen sc1 lds
  s_add_u32 s61, s61, 4096
  s_mov_b32 m0, s62
  s_add_u32 s62, s62, 4096
  buffer_load_dwordx4 v1, s[16:19], s61 offen sc1 lds
  s_add_u32 s61, s61, 4096
  s_mov_b32 m0, s62
  s_add_u32 s62, s62, 4096
  buffer_load_dwordx4 v1, s[16:19], s61 offen sc1 lds
  s_add_u32 s61, s61, 4096
  s_mov_b32 m0, s62
  s_add_u32 s62, s62, 4096
  buffer_load_dwordx4 v1, s[16:19], s61 offen sc1 lds
  s_add_u32 s61, s61, 4096
  s_lshl_b32 s62, s25, 10
  s_add_u32 s62, s62, 65536
  s_lshl_b32 s27, s48, 13
  s_add_u32 s27, s27, 73728
  v_cmp_ne_u32 vcc, s3, v110
  s_cbranch_vccz wo_dep_ok
  s_mov_b32 s31, 1048576
wo_dep_poll:
  buffer_load_dword v110, v109, s[12:15], s52 offen sc1
  s_waitcnt vmcnt(0)
wo_dep_chk:
  v_cmp_ne_u32 vcc, s3, v110
  s_cbranch_vccz wo_dep_ok
  s_mov_b64 exec, vcc
  s_sleep 4
  s_sub_u32 s31, s31, 1
  s_cmp_lg_u32 s31, 0
  s_cbranch_scc1 wo_dep_poll
wo_dep_ok:
  s_mov_b64 exec, -1
  s_or_b32 s27, s2, s25
  s_cmp_lg_u32 s27, 0
  s_cbranch_scc1 wo_noepoch
  v_mov_b32 v96, 0
  v_mov_b32 v97, s3
  s_mov_b32 s27, 270336
  s_mov_b64 exec, 1
  buffer_store_dword v97, v96, s[12:15], s27 offen
  s_mov_b64 exec, -1
wo_noepoch:
  s_add_u32 s26, s38, 0
  buffer_load_dwordx4 v[128:131], v1, s[8:11], s26 offen offset:0 sc1
  buffer_load_dwordx4 v[132:135], v1, s[8:11], s26 offen offset:1024 sc1
  buffer_load_dwordx4 v[136:139], v1, s[8:11], s26 offen offset:2048 sc1
  buffer_load_dwordx4 v[140:143], v1, s[8:11], s26 offen offset:3072 sc1
  s_add_u32 s26, s38, 4096
  buffer_load_dwordx4 v[144:147], v1, s[8:11], s26 offen offset:0 sc1
  buffer_load_dwordx4 v[148:151], v1, s[8:11], s26 offen offset:1024 sc1
  buffer_load_dwordx4 v[152:155], v1, s[8:11], s26 offen offset:2048 sc1
  buffer_load_dwordx4 v[156:159], v1, s[8:11], s26 offen offset:3072 sc1
  s_add_u32 s26, s38, 8192
  buffer_load_dwordx4 v[160:163], v1, s[8:11], s26 offen offset:0 sc1
  buffer_load_dwordx4 v[164:167], v1, s[8:11], s26 offen offset:1024 sc1
  buffer_load_dwordx4 v[168:171], v1, s[8:11], s26 offen offset:2048 sc1
  buffer_load_dwordx4 v[172:175], v1, s[8:11], s26 offen offset:3072 sc1
  s_add_u32 s26, s38, 12288
  buffer_load_dwordx4 v[176:179], v1, s[8:11], s26 offen offset:0 sc1
  buffer_load_dwordx4 v[180:183], v1, s[8:11], s26 offen offset:1024 sc1
  ds_read_b64_tr_b16 v[192:193], v8 offset:0
  ds_read_b64_tr_b16 v[194:195], v8 offset:1024
  ds_read_b64_tr_b16 v[196:197], v8 offset:2048
  ds_read_b64_tr_b16 v[198:199], v8 offset:3072
  ds_read_b64_tr_b16 v[200:201], v9 offset:0
  ds_read_b64_tr_b16 v[202:203], v9 offset:1024
  ds_read_b64_tr_b16 v[204:205], v9 offset:2048
  ds_read_b64_tr_b16 v[206:207], v9 offset:3072
  s_mov_b32 s32, 0xffff0000
  s_mov_b32 s33, 32768
  s_mov_b32 s21, 0
  s_waitcnt vmcnt(14) lgkmcnt(0)
  ds_read_b64_tr_b16 v[208:209], v8 offset:4096
  ds_read_b64_tr_b16 v[210:211], v8 offset:5120
  ds_read_b64_tr_b16 v[212:213], v8 offset:6144
  ds_read_b64_tr_b16 v[214:215], v8 offset:7168
  ds_read_b64_tr_b16 v[216:217], v9 offset:4096
  ds_read_b64_tr_b16 v[218:219], v9 offset:5120
  ds_read_b64_tr_b16 v[220:221], v9 offset:6144
  ds_read_b64_tr_b16 v[222:223], v9 offset:7168
  v_lshlrev_b32 v16, 16, v48
  v_and_b32 v17, s32, v48
  v_lshlrev_b32 v18, 16, v49
  v_and_b32 v19, s32, v49
  v_lshlrev_b32 v20, 16, v50
  v_and_b32 v21, s32, v50
  v_lshlrev_b32 v22, 16, v51
  v_and_b32 v23, s32, v51
  v_lshlrev_b32 v24, 16, v52
  v_and_b32 v25, s32, v52
  v_lshlrev_b32 v26, 16, v53
  v_and_b32 v27, s32, v53
  v_lshlrev_b32 v28, 16, v54
  v_and_b32 v29, s32, v54
  v_lshlrev_b32 v30, 16, v55
  v_and_b32 v31, s32, v55
  v_lshlrev_b32 v32, 16, v56
  v_and_b32 v33, s32, v56
  v_lshlrev_b32 v34, 16, v57
  v_and_b32 v35, s32, v57
  v_lshlrev_b32 v36, 16, v58
  v_and_b32 v37, s32, v58
  v_lshlrev_b32 v38, 16, v59
  v_and_b32 v39, s32, v59
  v_lshlrev_b32 v40, 16, v60
  v_and_b32 v41, s32, v60
  v_lshlrev_b32 v42, 16, v61
  v_and_b32 v43, s32, v61
  v_lshlrev_b32 v44, 16, v62
  v_and_b32 v45, s32, v62
  v_lshlrev_b32 v46, 16, v63
  v_and_b32 v47, s32, v63
.p2align 6
wo_loop:
  s_bitcmp1_b32 4, s21
  s_cbranch_scc1 wo_hook0
wo_ret0:
  s_waitcnt vmcnt(12) lgkmcnt(11)
  v_mfma_f32_32x32x16_bf16 v[64:79], v[192:195], v[128:131], v[64:79]
  ds_read_b64_tr_b16 v[224:225], v8 offset:8192
  ds_read_b64_tr_b16 v[226:227], v8 offset:9216
  v_mfma_f32_32x32x16_bf16 v[64:79], v[196:199], v[132:135], v[64:79]
  ds_read_b64_tr_b16 v[228:229], v8 offset:10240
  ds_read_b64_tr_b16 v[230:231], v8 offset:11264
  buffer_load_dwordx4 v[184:187], v1, s[8:11], s26 offen offset:2048 sc1
  s_waitcnt lgkmcnt(11)
  v_mfma_f32_32x32x16_bf16 v[80:95], v[200:203], v[128:131], v[80:95]
  ds_read_b64_tr_b16 v[232:233], v9 offset:8192
  ds_read_b64_tr_b16 v[234:235], v9 offset:9216
  v_mfma_f32_32x32x16_bf16 v[80:95], v[204:207], v[132:135], v[80:95]
  ds_read_b64_tr_b16 v[236:237], v9 offset:10240
  ds_read_b64_tr_b16 v[238:239], v9 offset:11264
  buffer_load_dwordx4 v[188:191], v1, s[8:11], s26 offen offset:3072 sc1
  s_bitcmp1_b32 10, s21
  s_cbranch_scc1 wo_hook1
wo_ret1:
  s_waitcnt vmcnt(12) lgkmcnt(11)
  v_mfma_f32_32x32x16_bf16 v[64:79], v[208:211], v[136:139], v[64:79]
  ds_read_b64_tr_b16 v[240:241], v8 offset:12288
  ds_read_b64_tr_b16 v[242:243], v8 offset:13312
  v_mfma_f32_32x32x16_bf16 v[64:79], v[212:215], v[140:143], v[64:79]
  ds_read_b64_tr_b16 v[244:245], v8 offset:14336
  ds_read_b64_tr_b16 v[246:247], v8 offset:15360
  s_add_u32 s26, s26, 4096
  buffer_load_dwordx4 v[128:131], v1, s[8:11], s26 offen offset:0 sc1
  s_waitcnt lgkmcnt(11)
  v_mfma_f32_32x32x16_bf16 v[80:95], v[216:219], v[136:139], v[80:95]
  ds_read_b64_tr_b16 v[248:249], v9 offset:12288
  ds_read_b64_tr_b16 v[250:251], v9 offset:13312
  v_mfma_f32_32x32x16_bf16 v[80:95], v[220:223], v[140:143], v[80:95]
  ds_read_b64_tr_b16 v[252:253], v9 offset:14336
  ds_read_b64_tr_b16 v[254:255], v9 offset:15360
  buffer_load_dwordx4 v[132:135], v1, s[8:11], s26 offen offset:1024 sc1
  s_bitcmp1_b32 3, s21
  s_cbranch_scc1 wo_hook2
wo_ret2:
  s_waitcnt vmcnt(12) lgkmcnt(11)
  v_mfma_f32_32x32x16_bf16 v[64:79], v[224:227], v[144:147], v[64:79]
  ds_read_b64_tr_b16 v[192:193], v8 offset:16384
  ds_read_b64_tr_b16 v[194:195], v8 offset:17408
  v_mfma_f32_32x32x16_bf16 v[64:79], v[228:231], v[148:151], v[64:79]
  ds_read_b64_tr_b16 v[196:197], v8 offset:18432
  ds_read_b64_tr_b16 v[198:199], v8 offset:19456
  buffer_load_dwordx4 v[136:139], v1, s[8:11], s26 offen offset:2048 sc1
  s_waitcnt lgkmcnt(11)
  v_mfma_f32_32x32x16_bf16 v[80:95], v[232:235], v[144:147], v[80:95]
  ds_read_b64_tr_b16 v[200:201], v9 offset:16384
  ds_read_b64_tr_b16 v[202:203], v9 offset:17408
  v_mfma_f32_32x32x16_bf16 v[80:95], v[236:239], v[148:151], v[80:95]
  ds_read_b64_tr_b16 v[204:205], v9 offset:18432
  ds_read_b64_tr_b16 v[206:207], v9 offset:19456
  buffer_load_dwordx4 v[140:143], v1, s[8:11], s26 offen offset:3072 sc1
  s_waitcnt vmcnt(12) lgkmcnt(11)
  v_mfma_f32_32x32x16_bf16 v[64:79], v[240:243], v[152:155], v[64:79]
  ds_read_b64_tr_b16 v[208:209], v8 offset:20480
  ds_read_b64_tr_b16 v[210:211], v8 offset:21504
  v_mfma_f32_32x32x16_bf16 v[64:79], v[244:247], v[156:159], v[64:79]
  ds_read_b64_tr_b16 v[212:213], v8 offset:22528
  ds_read_b64_tr_b16 v[214:215], v8 offset:23552
  s_add_u32 s26, s26, 4096
  buffer_load_dwordx4 v[144:147], v1, s[8:11], s26 offen offset:0 sc1
  s_waitcnt lgkmcnt(11)
  v_mfma_f32_32x32x16_bf16 v[80:95], v[248:251], v[152:155], v[80:95]
  ds_read_b64_tr_b16 v[216:217], v9 offset:20480
  ds_read_b64_tr_b16 v[218:219], v9 offset:21504
  v_mfma_f32_32x32x16_bf16 v[80:95], v[252:255], v[156:159], v[80:95]
  ds_read_b64_tr_b16 v[220:221], v9 offset:22528
  ds_read_b64_tr_b16 v[222:223], v9 offset:23552
  buffer_load_dwordx4 v[148:151], v1, s[8:11], s26 offen offset:1024 sc1
  s_waitcnt vmcnt(12) lgkmcnt(11)
  v_mfma_f32_32x32x16_bf16 v[64:79], v[192:195], v[160:163], v[64:79]
  ds_read_b64_tr_b16 v[224:225], v8 offset:24576
  ds_read_b64_tr_b16 v[226:227], v8 offset:25600
  v_mfma_f32_32x32x16_bf16 v[64:79], v[196:199], v[164:167], v[64:79]
  ds_read_b64_tr_b16 v[228:229], v8 offset:26624
  ds_read_b64_tr_b16 v[230:231], v8 offset:27648
  buffer_load_dwordx4 v[152:155], v1, s[8:11], s26 offen offset:2048 sc1
  s_waitcnt lgkmcnt(11)
  v_mfma_f32_32x32x16_bf16 v[80:95], v[200:203], v[160:163], v[80:95]
  ds_read_b64_tr_b16 v[232:233], v9 offset:24576
  ds_read_b64_tr_b16 v[234:235], v9 offset:25600
  v_mfma_f32_32x32x16_bf16 v[80:95], v[204:207], v[164:167], v[80:95]
  ds_read_b64_tr_b16 v[236:237], v9 offset:26624
  ds_read_b64_tr_b16 v[238:239], v9 offset:27648
  buffer_load_dwordx4 v[156:159], v1, s[8:11], s26 offen offset:3072 sc1
  s_bitcmp1_b32 4, s21
  s_cbranch_scc1 wo_hook5
wo_ret5:
  s_waitcnt vmcnt(12) lgkmcnt(11)
  v_mfma_f32_32x32x16_bf16 v[64:79], v[208:211], v[168:171], v[64:79]
  ds_read_b64_tr_b16 v[240:241], v10 offset:0
  ds_read_b64_tr_b16 v[242:243], v10 offset:1024
  v_mfma_f32_32x32x16_bf16 v[64:79], v[212:215], v[172:175], v[64:79]
  ds_read_b64_tr_b16 v[244:245], v10 offset:2048
  ds_read_b64_tr_b16 v[246:247], v10 offset:3072
  s_add_u32 s26, s26, 4096
  buffer_load_dwordx4 v[160:163], v1, s[8:11], s26 offen offset:0 sc1
  s_waitcnt lgkmcnt(11)
  v_mfma_f32_32x32x16_bf16 v[80:95], v[216:219], v[168:171], v[80:95]
  ds_read_b64_tr_b16 v[248:249], v11 offset:0
  ds_read_b64_tr_b16 v[250:251], v11 offset:1024
  v_mfma_f32_32x32x16_bf16 v[80:95], v[220:223], v[172:175], v[80:95]
  ds_read_b64_tr_b16 v[252:253], v11 offset:2048
  ds_read_b64_tr_b16 v[254:255], v11 offset:3072
  buffer_load_dwordx4 v[164:167], v1, s[8:11], s26 offen offset:1024 sc1
  s_cmp_eq_u32 s21, 2
  s_cselect_b32 s27, 4294905856, s33
  s_cmp_eq_u32 s21, 1
  s_cselect_b32 s39, 4294905856, s33
  s_waitcnt vmcnt(12) lgkmcnt(11)
  v_mfma_f32_32x32x16_bf16 v[64:79], v[224:227], v[176:179], v[64:79]
  v_add_u32 v8, s27, v8
  v_add_u32 v10, s39, v10
  ds_read_b64_tr_b16 v[192:193], v8 offset:0
  ds_read_b64_tr_b16 v[194:195], v8 offset:1024
  v_mfma_f32_32x32x16_bf16 v[64:79], v[228:231], v[180:183], v[64:79]
  ds_read_b64_tr_b16 v[196:197], v8 offset:2048
  ds_read_b64_tr_b16 v[198:199], v8 offset:3072
  buffer_load_dwordx4 v[168:171], v1, s[8:11], s26 offen offset:2048 sc1
  s_waitcnt lgkmcnt(11)
  v_mfma_f32_32x32x16_bf16 v[80:95], v[232:235], v[176:179], v[80:95]
  v_add_u32 v9, s27, v9
  v_add_u32 v11, s39, v11
  ds_read_b64_tr_b16 v[200:201], v9 offset:0
  ds_read_b64_tr_b16 v[202:203], v9 offset:1024
  v_mfma_f32_32x32x16_bf16 v[80:95], v[236:239], v[180:183], v[80:95]
  ds_read_b64_tr_b16 v[204:205], v9 offset:2048
  ds_read_b64_tr_b16 v[206:207], v9 offset:3072
  buffer_load_dwordx4 v[172:175], v1, s[8:11], s26 offen offset:3072 sc1
  s_waitcnt vmcnt(12) lgkmcnt(11)
  v_mfma_f32_32x32x16_bf16 v[64:79], v[240:243], v[184:187], v[64:79]
  ds_read_b64_tr_b16 v[208:209], v8 offset:4096
  ds_read_b64_tr_b16 v[210:211], v8 offset:5120
  v_mfma_f32_32x32x16_bf16 v[64:79], v[244:247], v[188:191], v[64:79]
  ds_read_b64_tr_b16 v[212:213], v8 offset:6144
  ds_read_b64_tr_b16 v[214:215], v8 offset:7168
  s_add_u32 s26, s26, 4096
  buffer_load_dwordx4 v[176:179], v1, s[8:11], s26 offen offset:0 sc1
  s_waitcnt lgkmcnt(11)
  v_mfma_f32_32x32x16_bf16 v[80:95], v[248:251], v[184:187], v[80:95]
  ds_read_b64_tr_b16 v[216:217], v9 offset:4096
  ds_read_b64_tr_b16 v[218:219], v9 offset:5120
  v_mfma_f32_32x32x16_bf16 v[80:95], v[252:255], v[188:191], v[80:95]
  ds_read_b64_tr_b16 v[220:221], v9 offset:6144
  ds_read_b64_tr_b16 v[222:223], v9 offset:7168
  buffer_load_dwordx4 v[180:183], v1, s[8:11], s26 offen offset:1024 sc1
  s_add_u32 s21, s21, 1
  s_cmp_lg_u32 s21, 4
  s_cbranch_scc1 wo_loop
  s_xor_b32 s27, s25, 3
  s_lshl_b32 s27, s27, 14
  v_add_u32 v15, s27, v15
  s_waitcnt vmcnt(0) lgkmcnt(0)
  v_xor_b32 v129, 16, v15
  v_xor_b32 v130, 64, v15
  v_xor_b32 v131, 80, v15
  v_xor_b32 v132, 128, v15
  v_xor_b32 v133, 144, v15
  v_xor_b32 v134, 192, v15
  v_xor_b32 v135, 208, v15
  s_barrier
  ds_read_b128 v[96:99], v15
  ds_read_b128 v[100:103], v129
  ds_read_b128 v[104:107], v130
  ds_read_b128 v[108:111], v131
  ds_read_b128 v[112:115], v132
  ds_read_b128 v[116:119], v133
  ds_read_b128 v[120:123], v134
  ds_read_b128 v[124:127], v135
  s_waitcnt lgkmcnt(4)
  v_pk_fma_f32 v[16:17], v[96:97], v[64:65], v[16:17]
  v_pk_fma_f32 v[18:19], v[98:99], v[66:67], v[18:19]
  v_pk_fma_f32 v[20:21], v[100:101], v[68:69], v[20:21]
  v_pk_fma_f32 v[22:23], v[102:103], v[70:71], v[22:23]
  v_pk_fma_f32 v[24:25], v[104:105], v[72:73], v[24:25]
  v_pk_fma_f32 v[26:27], v[106:107], v[74:75], v[26:27]
  v_pk_fma_f32 v[28:29], v[108:109], v[76:77], v[28:29]
  v_pk_fma_f32 v[30:31], v[110:111], v[78:79], v[30:31]
  v_cvt_pk_bf16_f32 v48, v16, v17
  v_cvt_pk_bf16_f32 v49, v18, v19
  v_cvt_pk_bf16_f32 v50, v20, v21
  v_cvt_pk_bf16_f32 v51, v22, v23
  v_cvt_pk_bf16_f32 v52, v24, v25
  v_cvt_pk_bf16_f32 v53, v26, v27
  v_cvt_pk_bf16_f32 v54, v28, v29
  v_cvt_pk_bf16_f32 v55, v30, v31
  s_nop 1
  v_permlane16_swap_b32 v48, v52
  v_permlane16_swap_b32 v49, v53
  v_permlane16_swap_b32 v50, v54
  v_permlane16_swap_b32 v51, v55
  buffer_store_dwordx4 v[48:51], v7, s[44:47], s50 offen offset:0 sc1
  buffer_store_dwordx4 v[52:55], v7, s[44:47], s51 offen offset:0 sc1
  s_waitcnt lgkmcnt(0)
  v_pk_fma_f32 v[32:33], v[112:113], v[80:81], v[32:33]
  v_pk_fma_f32 v[34:35], v[114:115], v[82:83], v[34:35]
  v_pk_fma_f32 v[36:37], v[116:117], v[84:85], v[36:37]
  v_pk_fma_f32 v[38:39], v[118:119], v[86:87], v[38:39]
  v_pk_fma_f32 v[40:41], v[120:121], v[88:89], v[40:41]
  v_pk_fma_f32 v[42:43], v[122:123], v[90:91], v[42:43]
  v_pk_fma_f32 v[44:45], v[124:125], v[92:93], v[44:45]
  v_pk_fma_f32 v[46:47], v[126:127], v[94:95], v[46:47]
  v_cvt_pk_bf16_f32 v56, v32, v33
  v_cvt_pk_bf16_f32 v57, v34, v35
  v_cvt_pk_bf16_f32 v58, v36, v37
  v_cvt_pk_bf16_f32 v59, v38, v39
  v_cvt_pk_bf16_f32 v60, v40, v41
  v_cvt_pk_bf16_f32 v61, v42, v43
  v_cvt_pk_bf16_f32 v62, v44, v45
  v_cvt_pk_bf16_f32 v63, v46, v47
  s_nop 1
  v_permlane16_swap_b32 v56, v60
  v_permlane16_swap_b32 v57, v61
  v_permlane16_swap_b32 v58, v62
  v_permlane16_swap_b32 v59, v63
  buffer_store_dwordx4 v[56:59], v7, s[44:47], s50 offen offset:64 sc1
  buffer_store_dwordx4 v[60:63], v7, s[44:47], s51 offen offset:64 sc1
  s_endpgm
wo_hook1:
  s_cmp_eq_u32 s21, 3
  s_cbranch_scc1 wo_hook1b
  ds_write_b32 v4, v6 offset:112
  s_waitcnt vmcnt(14)
  v_cmp_ne_u32 vcc, s3, v110
  s_cbranch_vccz wo_ret1
  s_mov_b32 s10, 0
  s_branch wo_ret1
wo_hook0:
  s_cmp_lg_u32 s10, 0
  s_cbranch_scc1 wo_ret0
  s_mov_b32 s31, 1048576
wo_dep2_poll:
  buffer_load_dword v110, v109, s[12:15], s53 offen sc1
  s_waitcnt vmcnt(0)
wo_dep2_chk:
  v_cmp_ne_u32 vcc, s3, v110
  s_cbranch_vccz wo_dep2_ok
  s_mov_b64 exec, vcc
  s_sleep 2
  s_sub_u32 s31, s31, 1
  s_cmp_lg_u32 s31, 0
  s_cbranch_scc1 wo_dep2_poll
wo_dep2_ok:
  s_mov_b64 exec, -1
  s_mov_b32 s10, 4194304
  s_add_u32 s26, s38, 32768
  buffer_load_dwordx4 v[128:131], v1, s[8:11], s26 offen offset:0 sc1
  buffer_load_dwordx4 v[132:135], v1, s[8:11], s26 offen offset:1024 sc1
  buffer_load_dwordx4 v[136:139], v1, s[8:11], s26 offen offset:2048 sc1
  buffer_load_dwordx4 v[140:143], v1, s[8:11], s26 offen offset:3072 sc1
  s_add_u32 s26, s38, 36864
  buffer_load_dwordx4 v[144:147], v1, s[8:11], s26 offen offset:0 sc1
  buffer_load_dwordx4 v[148:151], v1, s[8:11], s26 offen offset:1024 sc1
  buffer_load_dwordx4 v[152:155], v1, s[8:11], s26 offen offset:2048 sc1
  buffer_load_dwordx4 v[156:159], v1, s[8:11], s26 offen offset:3072 sc1
  s_add_u32 s26, s38, 40960
  buffer_load_dwordx4 v[160:163], v1, s[8:11], s26 offen offset:0 sc1
  buffer_load_dwordx4 v[164:167], v1, s[8:11], s26 offen offset:1024 sc1
  buffer_load_dwordx4 v[168:171], v1, s[8:11], s26 offen offset:2048 sc1
  buffer_load_dwordx4 v[172:175], v1, s[8:11], s26 offen offset:3072 sc1
  s_add_u32 s26, s38, 45056
  buffer_load_dwordx4 v[176:179], v1, s[8:11], s26 offen offset:0 sc1
  buffer_load_dwordx4 v[180:183], v1, s[8:11], s26 offen offset:1024 sc1
  s_branch wo_ret0
wo_hook1b:
  s_mov_b32 s10, 0
  s_branch wo_ret1
wo_hook2:
  s_cmp_lg_u32 s21, 0
  s_cbranch_scc1 wo_hook2b
  buffer_load_dword v110, v109, s[12:15], s53 offen sc1
  s_branch wo_ret2
wo_hook2b:
  s_mov_b32 s34, 8388608
att_f10_poll:
  ds_read_b128 v[96:99], v5 offset:112
  s_waitcnt lgkmcnt(0)
  v_and_b32 v96, v96, v97
  v_and_b32 v98, v98, v99
  v_and_b32 v96, v96, v98
  v_cmp_ne_u32 vcc, 1, v96
  s_cbranch_vccz att_f10_ok
  s_sleep 1
  s_sub_u32 s34, s34, 1
  s_cmp_lg_u32 s34, 0
  s_cbranch_scc1 att_f10_poll
att_f10_ok:
  s_mov_b32 m0, s62
  s_add_u32 s62, s62, 4096
  buffer_load_dwordx4 v1, s[16:19], s61 offen sc1 lds
  s_add_u32 s61, s61, 4096
  s_mov_b32 m0, s62
  s_add_u32 s62, s62, 4096
  buffer_load_dwordx4 v1, s[16:19], s61 offen sc1 lds
  s_add_u32 s61, s61, 4096
  s_mov_b32 m0, s62
  s_add_u32 s62, s62, 4096
  buffer_load_dwordx4 v1, s[16:19], s61 offen sc1 lds
  s_add_u32 s61, s61, 4096
  s_mov_b32 m0, s62
  s_add_u32 s62, s62, 4096
  buffer_load_dwordx4 v1, s[16:19], s61 offen sc1 lds
  s_add_u32 s61, s61, 4096
  s_mov_b32 m0, s62
  s_add_u32 s62, s62, 4096
  buffer_load_dwordx4 v1, s[16:19], s61 offen sc1 lds
  s_add_u32 s61, s61, 4096
  s_mov_b32 m0, s62
  s_add_u32 s62, s62, 4096
  buffer_load_dwordx4 v1, s[16:19], s61 offen sc1 lds
  s_add_u32 s61, s61, 4096
  s_mov_b32 m0, s62
  s_add_u32 s62, s62, 4096
  buffer_load_dwordx4 v1, s[16:19], s61 offen sc1 lds
  s_add_u32 s61, s61, 4096
  s_mov_b32 m0, s62
  s_add_u32 s62, s62, 4096
  buffer_load_dwordx4 v1, s[16:19], s61 offen sc1 lds
  s_add_u32 s61, s61, 4096
  s_mov_b32 m0, s62
  s_add_u32 s62, s62, 4096
  buffer_load_dwordx4 v1, s[16:19], s61 offen sc1 lds
  s_add_u32 s61, s61, 4096
  s_branch wo_ret2
wo_hook5:
  ds_write_b32 v4, v6 offset:128
  s_mov_b32 s34, 8388608
att_f22_poll:
  ds_read_b128 v[96:99], v5 offset:128
  s_waitcnt lgkmcnt(0)
  v_and_b32 v96, v96, v97
  v_and_b32 v98, v98, v99
  v_and_b32 v96, v96, v98
  v_cmp_ne_u32 vcc, 1, v96
  s_cbranch_vccz att_f22_ok
  s_sleep 1
  s_sub_u32 s34, s34, 1
  s_cmp_lg_u32 s34, 0
  s_cbranch_scc1 att_f22_poll
att_f22_ok:
  s_branch wo_ret5
att_chk2:
  s_cmp_eq_u32 s21, 5
  s_cbranch_scc1 att_chk5
  buffer_load_dword v216, v217, s[12:15], s33 offen sc1
  s_branch att_chk2_ret
att_chk5:
  v_cmp_ne_u32 vcc, s3, v216
  s_cbranch_vccz att_c2_ok
  s_mov_b32 s31, 1048576
att_c2_poll:
  buffer_load_dword v216, v217, s[12:15], s33 offen sc1
  s_waitcnt vmcnt(0)
att_c2_chk:
  v_cmp_ne_u32 vcc, s3, v216
  s_cbranch_vccz att_c2_ok
  s_mov_b64 exec, vcc
  s_sleep 2
  s_sub_u32 s31, s31, 1
  s_cmp_lg_u32 s31, 0
  s_cbranch_scc1 att_c2_poll
att_c2_ok:
  s_mov_b64 exec, -1
  s_branch att_chk2_ret
att_fallback:
  s_mov_b32 s20, s24
  s_mov_b32 s21, 32
  v_mov_b32 v220, 0xff800000
  v_mov_b32 v216, 0
  v_mov_b64 v[40:41], 0
  v_mov_b64 v[42:43], 0
  v_mov_b64 v[44:45], 0
  v_mov_b64 v[46:47], 0
  v_mov_b64 v[48:49], 0
  v_mov_b64 v[50:51], 0
  v_mov_b64 v[52:53], 0
  v_mov_b64 v[54:55], 0
att_fb0:
  s_waitcnt vmcnt(0)
  buffer_load_dwordx4 v[152:155], v1, s[4:7], s20 offen offset:0
  buffer_load_dwordx4 v[156:159], v1, s[4:7], s20 offen offset:1024
  buffer_load_dwordx4 v[160:163], v1, s[4:7], s20 offen offset:2048
  buffer_load_dwordx4 v[164:167], v1, s[4:7], s20 offen offset:3072
  s_add_u32 s20, s20, 4096
  s_waitcnt vmcnt(0)
  v_mfma_f32_32x32x16_bf16 v[112:127], v[152:155], v[8:11], 0
  v_mfma_f32_32x32x16_bf16 v[112:127], v[156:159], v[12:15], v[112:127]
  s_nop 15
  v_max3_f32 v224, v112, v113, v220
  v_max3_f32 v224, v114, v115, v224
  v_max3_f32 v224, v116, v117, v224
  v_max3_f32 v224, v118, v119, v224
  v_max3_f32 v224, v120, v121, v224
  v_max3_f32 v224, v122, v123, v224
  v_max3_f32 v224, v124, v125, v224
  v_max3_f32 v224, v126, v127, v224
  v_mov_b32 v225, v224
  s_nop 1
  v_permlane32_swap_b32 v224, v225
  v_max_f32 v224, v224, v225
  v_sub_f32 v226, v220, v224
  v_exp_f32 v226, v226
  v_mov_b32 v220, v224
  v_sub_f32 v112, v112, v224
  v_sub_f32 v113, v113, v224
  v_sub_f32 v114, v114, v224
  v_sub_f32 v115, v115, v224
  v_sub_f32 v116, v116, v224
  v_sub_f32 v117, v117, v224
  v_sub_f32 v118, v118, v224
  v_sub_f32 v119, v119, v224
  v_sub_f32 v120, v120, v224
  v_sub_f32 v121, v121, v224
  v_sub_f32 v122, v122, v224
  v_sub_f32 v123, v123, v224
  v_sub_f32 v124, v124, v224
  v_sub_f32 v125, v125, v224
  v_sub_f32 v126, v126, v224
  v_sub_f32 v127, v127, v224
  v_exp_f32 v112, v112
  v_exp_f32 v113, v113
  v_exp_f32 v114, v114
  v_exp_f32 v115, v115
  v_exp_f32 v116, v116
  v_exp_f32 v117, v117
  v_exp_f32 v118, v118
  v_exp_f32 v119, v119
  v_exp_f32 v120, v120
  v_exp_f32 v121, v121
  v_exp_f32 v122, v122
  v_exp_f32 v123, v123
  v_exp_f32 v124, v124
  v_exp_f32 v125, v125
  v_exp_f32 v126, v126
  v_exp_f32 v127, v127
  v_mul_f32 v216, v216, v226
  v_mul_f32 v40, v40, v226
  v_mul_f32 v41, v41, v226
  v_mul_f32 v42, v42, v226
  v_mul_f32 v43, v43, v226
  v_mul_f32 v44, v44, v226
  v_mul_f32 v45, v45, v226
  v_mul_f32 v46, v46, v226
  v_mul_f32 v47, v47, v226
  v_mul_f32 v48, v48, v226
  v_mul_f32 v49, v49, v226
  v_mul_f32 v50, v50, v226
  v_mul_f32 v51, v51, v226
  v_mul_f32 v52, v52, v226
  v_mul_f32 v53, v53, v226
  v_mul_f32 v54, v54, v226
  v_mul_f32 v55, v55, v226
  v_add_f32 v216, v216, v112
  v_add_f32 v216, v216, v113
  v_add_f32 v216, v216, v114
  v_add_f32 v216, v216, v115
  v_add_f32 v216, v216, v116
  v_add_f32 v216, v216, v117
  v_add_f32 v216, v216, v118
  v_add_f32 v216, v216, v119
  v_add_f32 v216, v216, v120
  v_add_f32 v216, v216, v121
  v_add_f32 v216, v216, v122
  v_add_f32 v216, v216, v123
  v_add_f32 v216, v216, v124
  v_add_f32 v216, v216, v125
  v_add_f32 v216, v216, v126
  v_add_f32 v216, v216, v127
  v_cvt_pk_bf16_f32 v144, v112, v113
  v_cvt_pk_bf16_f32 v145, v114, v115
  v_cvt_pk_bf16_f32 v146, v116, v117
  v_cvt_pk_bf16_f32 v147, v118, v119
  v_cvt_pk_bf16_f32 v148, v120, v121
  v_cvt_pk_bf16_f32 v149, v122, v123
  v_cvt_pk_bf16_f32 v150, v124, v125
  v_cvt_pk_bf16_f32 v151, v126, v127
  s_nop 1
  v_mfma_f32_32x32x16_bf16 v[40:55], v[160:163], v[144:147], v[40:55]
  v_mfma_f32_32x32x16_bf16 v[40:55], v[164:167], v[148:151], v[40:55]
  s_nop 15
  s_sub_u32 s21, s21, 1
  s_cmp_lg_u32 s21, 0
  s_cbranch_scc1 att_fb0
  v_mov_b32 v225, v216
  s_nop 1
  v_permlane32_swap_b32 v216, v225
  v_add_f32 v216, v216, v225
  s_mov_b32 s20, s24
  s_mov_b32 s21, 32
  v_mov_b32 v221, 0xff800000
  v_mov_b32 v217, 0
  v_mov_b64 v[56:57], 0
  v_mov_b64 v[58:59], 0
  v_mov_b64 v[60:61], 0
  v_mov_b64 v[62:63], 0
  v_mov_b64 v[64:65], 0
  v_mov_b64 v[66:67], 0
  v_mov_b64 v[68:69], 0
  v_mov_b64 v[70:71], 0
att_fb1:
  s_waitcnt vmcnt(0)
  buffer_load_dwordx4 v[152:155], v1, s[4:7], s20 offen offset:0
  buffer_load_dwordx4 v[156:159], v1, s[4:7], s20 offen offset:1024
  buffer_load_dwordx4 v[160:163], v1, s[4:7], s20 offen offset:2048
  buffer_load_dwordx4 v[164:167], v1, s[4:7], s20 offen offset:3072
  s_add_u32 s20, s20, 4096
  s_waitcnt vmcnt(0)
  v_mfma_f32_32x32x16_bf16 v[112:127], v[152:155], v[16:19], 0
  v_mfma_f32_32x32x16_bf16 v[112:127], v[156:159], v[20:23], v[112:127]
  s_nop 15
  v_max3_f32 v224, v112, v113, v221
  v_max3_f32 v224, v114, v115, v224
  v_max3_f32 v224, v116, v117, v224
  v_max3_f32 v224, v118, v119, v224
  v_max3_f32 v224, v120, v121, v224
  v_max3_f32 v224, v122, v123, v224
  v_max3_f32 v224, v124, v125, v224
  v_max3_f32 v224, v126, v127, v224
  v_mov_b32 v225, v224
  s_nop 1
  v_permlane32_swap_b32 v224, v225
  v_max_f32 v224, v224, v225
  v_sub_f32 v226, v221, v224
  v_exp_f32 v226, v226
  v_mov_b32 v221, v224
  v_sub_f32 v112, v112, v224
  v_sub_f32 v113, v113, v224
  v_sub_f32 v114, v114, v224
  v_sub_f32 v115, v115, v224
  v_sub_f32 v116, v116, v224
  v_sub_f32 v117, v117, v224
  v_sub_f32 v118, v118, v224
  v_sub_f32 v119, v119, v224
  v_sub_f32 v120, v120, v224
  v_sub_f32 v121, v121, v224
  v_sub_f32 v122, v122, v224
  v_sub_f32 v123, v123, v224
  v_sub_f32 v124, v124, v224
  v_sub_f32 v125, v125, v224
  v_sub_f32 v126, v126, v224
  v_sub_f32 v127, v127, v224
  v_exp_f32 v112, v112
  v_exp_f32 v113, v113
  v_exp_f32 v114, v114
  v_exp_f32 v115, v115
  v_exp_f32 v116, v116
  v_exp_f32 v117, v117
  v_exp_f32 v118, v118
  v_exp_f32 v119, v119
  v_exp_f32 v120, v120
  v_exp_f32 v121, v121
  v_exp_f32 v122, v122
  v_exp_f32 v123, v123
  v_exp_f32 v124, v124
  v_exp_f32 v125, v125
  v_exp_f32 v126, v126
  v_exp_f32 v127, v127
  v_mul_f32 v217, v217, v226
  v_mul_f32 v56, v56, v226
  v_mul_f32 v57, v57, v226
  v_mul_f32 v58, v58, v226
  v_mul_f32 v59, v59, v226
  v_mul_f32 v60, v60, v226
  v_mul_f32 v61, v61, v226
  v_mul_f32 v62, v62, v226
  v_mul_f32 v63, v63, v226
  v_mul_f32 v64, v64, v226
  v_mul_f32 v65, v65, v226
  v_mul_f32 v66, v66, v226
  v_mul_f32 v67, v67, v226
  v_mul_f32 v68, v68, v226
  v_mul_f32 v69, v69, v226
  v_mul_f32 v70, v70, v226
  v_mul_f32 v71, v71, v226
  v_add_f32 v217, v217, v112
  v_add_f32 v217, v217, v113
  v_add_f32 v217, v217, v114
  v_add_f32 v217, v217, v115
  v_add_f32 v217, v217, v116
  v_add_f32 v217, v217, v117
  v_add_f32 v217, v217, v118
  v_add_f32 v217, v217, v119
  v_add_f32 v217, v217, v120
  v_add_f32 v217, v217, v121
  v_add_f32 v217, v217, v122
  v_add_f32 v217, v217, v123
  v_add_f32 v217, v217, v124
  v_add_f32 v217, v217, v125
  v_add_f32 v217, v217, v126
  v_add_f32 v217, v217, v127
  v_cvt_pk_bf16_f32 v144, v112, v113
  v_cvt_pk_bf16_f32 v145, v114, v115
  v_cvt_pk_bf16_f32 v146, v116, v117
  v_cvt_pk_bf16_f32 v147, v118, v119
  v_cvt_pk_bf16_f32 v148, v120, v121
  v_cvt_pk_bf16_f32 v149, v122, v123
  v_cvt_pk_bf16_f32 v150, v124, v125
  v_cvt_pk_bf16_f32 v151, v126, v127
  s_nop 1
  v_mfma_f32_32x32x16_bf16 v[56:71], v[160:163], v[144:147], v[56:71]
  v_mfma_f32_32x32x16_bf16 v[56:71], v[164:167], v[148:151], v[56:71]
  s_nop 15
  s_sub_u32 s21, s21, 1
  s_cmp_lg_u32 s21, 0
  s_cbranch_scc1 att_fb1
  v_mov_b32 v225, v217
  s_nop 1
  v_permlane32_swap_b32 v217, v225
  v_add_f32 v217, v217, v225
  s_mov_b32 s20, s24
  s_mov_b32 s21, 32
  v_mov_b32 v222, 0xff800000
  v_mov_b32 v218, 0
  v_mov_b64 v[72:73], 0
  v_mov_b64 v[74:75], 0
  v_mov_b64 v[76:77], 0
  v_mov_b64 v[78:79], 0
  v_mov_b64 v[80:81], 0
  v_mov_b64 v[82:83], 0
  v_mov_b64 v[84:85], 0
  v_mov_b64 v[86:87], 0
att_fb2:
  s_waitcnt vmcnt(0)
  buffer_load_dwordx4 v[152:155], v1, s[4:7], s20 offen offset:0
  buffer_load_dwordx4 v[156:159], v1, s[4:7], s20 offen offset:1024
  buffer_load_dwordx4 v[160:163], v1, s[4:7], s20 offen offset:2048
  buffer_load_dwordx4 v[164:167], v1, s[4:7], s20 offen offset:3072
  s_add_u32 s20, s20, 4096
  s_waitcnt vmcnt(0)
  v_mfma_f32_32x32x16_bf16 v[112:127], v[152:155], v[24:27], 0
  v_mfma_f32_32x32x16_bf16 v[112:127], v[156:159], v[28:31], v[112:127]
  s_nop 15
  v_max3_f32 v224, v112, v113, v222
  v_max3_f32 v224, v114, v115, v224
  v_max3_f32 v224, v116, v117, v224
  v_max3_f32 v224, v118, v119, v224
  v_max3_f32 v224, v120, v121, v224
  v_max3_f32 v224, v122, v123, v224
  v_max3_f32 v224, v124, v125, v224
  v_max3_f32 v224, v126, v127, v224
  v_mov_b32 v225, v224
  s_nop 1
  v_permlane32_swap_b32 v224, v225
  v_max_f32 v224, v224, v225
  v_sub_f32 v226, v222, v224
  v_exp_f32 v226, v226
  v_mov_b32 v222, v224
  v_sub_f32 v112, v112, v224
  v_sub_f32 v113, v113, v224
  v_sub_f32 v114, v114, v224
  v_sub_f32 v115, v115, v224
  v_sub_f32 v116, v116, v224
  v_sub_f32 v117, v117, v224
  v_sub_f32 v118, v118, v224
  v_sub_f32 v119, v119, v224
  v_sub_f32 v120, v120, v224
  v_sub_f32 v121, v121, v224
  v_sub_f32 v122, v122, v224
  v_sub_f32 v123, v123, v224
  v_sub_f32 v124, v124, v224
  v_sub_f32 v125, v125, v224
  v_sub_f32 v126, v126, v224
  v_sub_f32 v127, v127, v224
  v_exp_f32 v112, v112
  v_exp_f32 v113, v113
  v_exp_f32 v114, v114
  v_exp_f32 v115, v115
  v_exp_f32 v116, v116
  v_exp_f32 v117, v117
  v_exp_f32 v118, v118
  v_exp_f32 v119, v119
  v_exp_f32 v120, v120
  v_exp_f32 v121, v121
  v_exp_f32 v122, v122
  v_exp_f32 v123, v123
  v_exp_f32 v124, v124
  v_exp_f32 v125, v125
  v_exp_f32 v126, v126
  v_exp_f32 v127, v127
  v_mul_f32 v218, v218, v226
  v_mul_f32 v72, v72, v226
  v_mul_f32 v73, v73, v226
  v_mul_f32 v74, v74, v226
  v_mul_f32 v75, v75, v226
  v_mul_f32 v76, v76, v226
  v_mul_f32 v77, v77, v226
  v_mul_f32 v78, v78, v226
  v_mul_f32 v79, v79, v226
  v_mul_f32 v80, v80, v226
  v_mul_f32 v81, v81, v226
  v_mul_f32 v82, v82, v226
  v_mul_f32 v83, v83, v226
  v_mul_f32 v84, v84, v226
  v_mul_f32 v85, v85, v226
  v_mul_f32 v86, v86, v226
  v_mul_f32 v87, v87, v226
  v_add_f32 v218, v218, v112
  v_add_f32 v218, v218, v113
  v_add_f32 v218, v218, v114
  v_add_f32 v218, v218, v115
  v_add_f32 v218, v218, v116
  v_add_f32 v218, v218, v117
  v_add_f32 v218, v218, v118
  v_add_f32 v218, v218, v119
  v_add_f32 v218, v218, v120
  v_add_f32 v218, v218, v121
  v_add_f32 v218, v218, v122
  v_add_f32 v218, v218, v123
  v_add_f32 v218, v218, v124
  v_add_f32 v218, v218, v125
  v_add_f32 v218, v218, v126
  v_add_f32 v218, v218, v127
  v_cvt_pk_bf16_f32 v144, v112, v113
  v_cvt_pk_bf16_f32 v145, v114, v115
  v_cvt_pk_bf16_f32 v146, v116, v117
  v_cvt_pk_bf16_f32 v147, v118, v119
  v_cvt_pk_bf16_f32 v148, v120, v121
  v_cvt_pk_bf16_f32 v149, v122, v123
  v_cvt_pk_bf16_f32 v150, v124, v125
  v_cvt_pk_bf16_f32 v151, v126, v127
  s_nop 1
  v_mfma_f32_32x32x16_bf16 v[72:87], v[160:163], v[144:147], v[72:87]
  v_mfma_f32_32x32x16_bf16 v[72:87], v[164:167], v[148:151], v[72:87]
  s_nop 15
  s_sub_u32 s21, s21, 1
  s_cmp_lg_u32 s21, 0
  s_cbranch_scc1 att_fb2
  v_mov_b32 v225, v218
  s_nop 1
  v_permlane32_swap_b32 v218, v225
  v_add_f32 v218, v218, v225
  s_mov_b32 s20, s24
  s_mov_b32 s21, 32
  v_mov_b32 v223, 0xff800000
  v_mov_b32 v219, 0
  v_mov_b64 v[88:89], 0
  v_mov_b64 v[90:91], 0
  v_mov_b64 v[92:93], 0
  v_mov_b64 v[94:95], 0
  v_mov_b64 v[96:97], 0
  v_mov_b64 v[98:99], 0
  v_mov_b64 v[100:101], 0
  v_mov_b64 v[102:103], 0
att_fb3:
  s_waitcnt vmcnt(0)
  buffer_load_dwordx4 v[152:155], v1, s[4:7], s20 offen offset:0
  buffer_load_dwordx4 v[156:159], v1, s[4:7], s20 offen offset:1024
  buffer_load_dwordx4 v[160:163], v1, s[4:7], s20 offen offset:2048
  buffer_load_dwordx4 v[164:167], v1, s[4:7], s20 offen offset:3072
  s_add_u32 s20, s20, 4096
  s_waitcnt vmcnt(0)
  v_mfma_f32_32x32x16_bf16 v[112:127], v[152:155], v[32:35], 0
  v_mfma_f32_32x32x16_bf16 v[112:127], v[156:159], v[36:39], v[112:127]
  s_nop 15
  v_max3_f32 v224, v112, v113, v223
  v_max3_f32 v224, v114, v115, v224
  v_max3_f32 v224, v116, v117, v224
  v_max3_f32 v224, v118, v119, v224
  v_max3_f32 v224, v120, v121, v224
  v_max3_f32 v224, v122, v123, v224
  v_max3_f32 v224, v124, v125, v224
  v_max3_f32 v224, v126, v127, v224
  v_mov_b32 v225, v224
  s_nop 1
  v_permlane32_swap_b32 v224, v225
  v_max_f32 v224, v224, v225
  v_sub_f32 v226, v223, v224
  v_exp_f32 v226, v226
  v_mov_b32 v223, v224
  v_sub_f32 v112, v112, v224
  v_sub_f32 v113, v113, v224
  v_sub_f32 v114, v114, v224
  v_sub_f32 v115, v115, v224
  v_sub_f32 v116, v116, v224
  v_sub_f32 v117, v117, v224
  v_sub_f32 v118, v118, v224
  v_sub_f32 v119, v119, v224
  v_sub_f32 v120, v120, v224
  v_sub_f32 v121, v121, v224
  v_sub_f32 v122, v122, v224
  v_sub_f32 v123, v123, v224
  v_sub_f32 v124, v124, v224
  v_sub_f32 v125, v125, v224
  v_sub_f32 v126, v126, v224
  v_sub_f32 v127, v127, v224
  v_exp_f32 v112, v112
  v_exp_f32 v113, v113
  v_exp_f32 v114, v114
  v_exp_f32 v115, v115
  v_exp_f32 v116, v116
  v_exp_f32 v117, v117
  v_exp_f32 v118, v118
  v_exp_f32 v119, v119
  v_exp_f32 v120, v120
  v_exp_f32 v121, v121
  v_exp_f32 v122, v122
  v_exp_f32 v123, v123
  v_exp_f32 v124, v124
  v_exp_f32 v125, v125
  v_exp_f32 v126, v126
  v_exp_f32 v127, v127
  v_mul_f32 v219, v219, v226
  v_mul_f32 v88, v88, v226
  v_mul_f32 v89, v89, v226
  v_mul_f32 v90, v90, v226
  v_mul_f32 v91, v91, v226
  v_mul_f32 v92, v92, v226
  v_mul_f32 v93, v93, v226
  v_mul_f32 v94, v94, v226
  v_mul_f32 v95, v95, v226
  v_mul_f32 v96, v96, v226
  v_mul_f32 v97, v97, v226
  v_mul_f32 v98, v98, v226
  v_mul_f32 v99, v99, v226
  v_mul_f32 v100, v100, v226
  v_mul_f32 v101, v101, v226
  v_mul_f32 v102, v102, v226
  v_mul_f32 v103, v103, v226
  v_add_f32 v219, v219, v112
  v_add_f32 v219, v219, v113
  v_add_f32 v219, v219, v114
  v_add_f32 v219, v219, v115
  v_add_f32 v219, v219, v116
  v_add_f32 v219, v219, v117
  v_add_f32 v219, v219, v118
  v_add_f32 v219, v219, v119
  v_add_f32 v219, v219, v120
  v_add_f32 v219, v219, v121
  v_add_f32 v219, v219, v122
  v_add_f32 v219, v219, v123
  v_add_f32 v219, v219, v124
  v_add_f32 v219, v219, v125
  v_add_f32 v219, v219, v126
  v_add_f32 v219, v219, v127
  v_cvt_pk_bf16_f32 v144, v112, v113
  v_cvt_pk_bf16_f32 v145, v114, v115
  v_cvt_pk_bf16_f32 v146, v116, v117
  v_cvt_pk_bf16_f32 v147, v118, v119
  v_cvt_pk_bf16_f32 v148, v120, v121
  v_cvt_pk_bf16_f32 v149, v122, v123
  v_cvt_pk_bf16_f32 v150, v124, v125
  v_cvt_pk_bf16_f32 v151, v126, v127
  s_nop 1
  v_mfma_f32_32x32x16_bf16 v[88:103], v[160:163], v[144:147], v[88:103]
  v_mfma_f32_32x32x16_bf16 v[88:103], v[164:167], v[148:151], v[88:103]
  s_nop 15
  s_sub_u32 s21, s21, 1
  s_cmp_lg_u32 s21, 0
  s_cbranch_scc1 att_fb3
  v_mov_b32 v225, v219
  s_nop 1
  v_permlane32_swap_b32 v219, v225
  v_add_f32 v219, v219, v225
  s_branch att_fin
mega_down:
  s_setprio 2
  v_mov_b32 v3, 163392
  s_mov_b32 s31, 8388608
mega_hw_poll:
  ds_read_b128 v[4:7], v3 offset:0
  s_waitcnt lgkmcnt(0)
  v_and_b32 v4, v4, v5
  v_and_b32 v6, v6, v7
  v_and_b32 v4, v4, v6
  v_cmp_ne_u32 vcc, 1, v4
  s_cbranch_vccz mega_hw_ok
  s_sleep 1
  s_sub_u32 s31, s31, 1
  s_cmp_lg_u32 s31, 0
  s_cbranch_scc1 mega_hw_poll
mega_hw_ok:
  s_sub_u32 s47, s39, 8192
  buffer_store_dwordx4 v[224:227], v1, s[4:7], s39 offen offset:0 sc1
  s_waitcnt vmcnt(3)
  buffer_store_dwordx4 v[228:231], v1, s[4:7], s39 offen offset:1024 sc1
  s_waitcnt vmcnt(3)
  buffer_store_dwordx4 v[232:235], v1, s[4:7], s39 offen offset:2048 sc1
  s_waitcnt vmcnt(3)
  buffer_store_dwordx4 v[236:239], v1, s[4:7], s39 offen offset:3072 sc1
  s_waitcnt vmcnt(3)
  s_cmp_eq_u32 s27, 3
  s_cbranch_scc1 mega_hC
  s_add_u32 s46, s39, 16384
  s_add_u32 s48, s47, 16384
  buffer_store_dwordx4 v[240:243], v1, s[4:7], s46 offen offset:0 sc1
  s_waitcnt vmcnt(3)
  buffer_store_dwordx4 v[244:247], v1, s[4:7], s46 offen offset:1024 sc1
  s_waitcnt vmcnt(3)
  buffer_store_dwordx4 v[248:251], v1, s[4:7], s46 offen offset:2048 sc1
  s_waitcnt vmcnt(3)
  buffer_store_dwordx4 v[252:255], v1, s[4:7], s46 offen offset:3072 sc1
  s_waitcnt vmcnt(3)
  s_branch mega_hdone
mega_hC:
  buffer_store_dwordx4 v[52:55], v12, s[8:11], s42 offen sc1
  buffer_store_dwordx4 v[56:59], v12, s[8:11], s43 offen sc1
  s_add_u32 s46, s51, 4261888
  buffer_store_dwordx4 v[76:79], v10, s[8:11], s46 offen sc1
  s_add_u32 s46, s51, 4262144
  buffer_store_dwordx4 v[80:83], v10, s[8:11], s46 offen sc1
  s_add_u32 s46, s51, 4786176
  buffer_store_dwordx4 v[84:87], v10, s[8:11], s46 offen sc1
  s_add_u32 s46, s51, 4786432
  buffer_store_dwordx4 v[88:91], v10, s[8:11], s46 offen sc1
mega_hdone:
  s_load_dwordx2 s[34:35], s[0:1], 48
  s_load_dwordx2 s[16:17], s[0:1], 16
  s_sub_u32 s24, s25, 4
  s_bfe_u32 s28, s2, 0x20001
  s_lshl_b32 s28, s28, 2
  s_bfe_u32 s30, s2, 0x20003
  s_add_u32 s28, s28, s30
  s_and_b32 s29, s2, 1
  s_lshl_b32 s29, s29, 3
  s_lshr_b32 s30, s2, 5
  s_add_u32 s29, s29, s30
  v_add_u32 v2, 4096, v1
  v_and_b32 v12, 7, v0
  v_lshrrev_b32 v13, 4, v0
  v_lshlrev_b32 v13, 1, v13
  v_xor_b32 v12, v12, v13
  v_lshlrev_b32 v12, 4, v12
  v_lshrrev_b32 v13, 3, v0
  v_lshl_add_u32 v6, v13, 11, v12
  v_bfe_u32 v13, v0, 3, 2
  v_lshlrev_b32 v13, 5, v13
  v_and_b32 v14, 3, v0
  v_lshl_add_u32 v13, v14, 3, v13
  v_lshrrev_b32 v12, 2, v0
  v_lshl_add_u32 v12, v12, 7, v13
  s_lshl_b32 s22, s24, 14
  v_add_u32 v8, s22, v12
  v_xor_b32 v9, 32, v8
  v_xor_b32 v10, 64, v8
  v_xor_b32 v11, 96, v8
  s_mul_i32 s20, s28, 112
  s_mul_i32 s30, s24, 28
  s_add_u32 s20, s20, s30
  s_lshl_b32 s20, s20, 13
  s_mul_i32 s21, s24, 1835008
  s_lshl_b32 s30, s29, 7
  s_add_u32 s31, s21, 1835008
  s_sub_u32 s31, s31, s30
  s_waitcnt lgkmcnt(0)
  s_add_u32 s4, s36, 16777216
  s_addc_u32 s5, s37, 0
  s_mov_b32 s6, 14680064
  s_mov_b32 s7, 0x20000
  s_add_u32 s8, s34, s30
  s_addc_u32 s9, s35, 0
  s_mov_b32 s10, s31
  s_mov_b32 s11, 0x20000
  s_add_u32 s12, s36, 41943040
  s_addc_u32 s13, s37, 0
  s_mov_b32 s14, 270464
  s_mov_b32 s15, 0x20000
  s_sub_u32 s31, 2097152, s30
  s_add_u32 s16, s16, s30
  s_addc_u32 s17, s17, 0
  s_mov_b32 s18, s31
  s_mov_b32 s19, 0x20000
  v_and_b32 v4, 7, v0
  v_bfe_u32 v5, v0, 4, 1
  v_lshlrev_b32 v5, 2, v5
  v_xor_b32 v4, v4, v5
  v_lshlrev_b32 v4, 4, v4
  v_lshrrev_b32 v5, 3, v0
  v_lshl_add_u32 v7, v5, 11, v4
  s_lshl_b32 s61, s24, 14
  s_lshl_b32 s62, s24, 10
  s_add_u32 s62, s62, 65536
  s_lshl_b32 s27, s24, 2
  s_add_u32 s27, s27, 163488
  v_mov_b32 v4, s27
  v_mov_b32 v5, 1
  v_mov_b32 v6, v1
  s_mul_i32 s21, s24, 114688
  s_mul_i32 s30, s29, 458752
  s_add_u32 s30, s30, 54525952
  s_add_u32 s31, s21, 114688
  s_add_u32 s8, s36, s30
  s_addc_u32 s9, s37, 0
  s_mov_b32 s10, s31
  s_mov_b32 s11, 0x20000
  v_mov_b32 v7, v1
  s_lshl_b32 s30, s29, 17
  s_add_u32 s30, s30, 62914560
  s_add_u32 s16, s36, s30
  s_addc_u32 s17, s37, 0
  s_mov_b32 s18, 131072
  s_mov_b32 s19, 0x20000
  s_lshl_b32 s61, s24, 10
  s_waitcnt vmcnt(0)
  v_mov_b32 v16, 163380
  v_mov_b32 v17, 1
  s_mov_b64 exec, 1
  ds_add_rtn_u32 v18, v16, v17
  s_waitcnt lgkmcnt(0)
  v_cmp_eq_u32 vcc, 7, v18
  s_cbranch_vccz fh_nosig
  s_mov_b32 exec_lo, -1
  s_mov_b32 exec_hi, 0
  v_lshlrev_b32 v16, 2, v0
  v_mov_b32 v17, s3
  buffer_store_dword v17, v16, s[12:15], s60 offen sc1
  buffer_store_dword v17, v16, s[12:15], s63 offen sc1
  s_mov_b64 exec, -1
fh_nosig:
  s_mov_b64 exec, -1
  s_lshr_b32 s30, s28, 1
  s_lshl_b32 s30, s30, 12
  s_add_u32 s30, s30, 40960
  v_mov_b32 v17, 163388
  s_cmp_lg_u32 s25, 4
  s_cbranch_scc1 down_dep_follow
  v_and_b32 v18, 31, v0
  v_lshlrev_b32 v18, 7, v18
  s_mov_b32 s31, 1048576
down_dep_poll:
  buffer_load_dword v16, v18, s[12:15], s30 offen sc1
  s_waitcnt vmcnt(0)
down_dep_chk:
  v_cmp_ne_u32 vcc, s3, v16
  s_cbranch_vccz down_dep_ok
  s_mov_b64 exec, vcc
  s_sleep 2
  s_sub_u32 s31, s31, 1
  s_cmp_lg_u32 s31, 0
  s_cbranch_scc1 down_dep_poll
down_dep_ok:
  s_mov_b64 exec, -1
  v_mov_b32 v16, 1
  ds_write_b32 v17, v16
  s_branch down_dep_go
down_dep_follow:
  s_mov_b32 s31, 8388608
down_depf_poll:
  ds_read_b32 v16, v17 offset:0
  s_waitcnt lgkmcnt(0)
  v_cmp_ne_u32 vcc, 1, v16
  s_cbranch_vccz down_depf_ok
  s_sleep 1
  s_sub_u32 s31, s31, 1
  s_cmp_lg_u32 s31, 0
  s_cbranch_scc1 down_depf_poll
down_depf_ok:
down_dep_go:
  s_add_u32 s27, s21, 0
  s_add_u32 m0, s22, 0
  s_nop 0
  buffer_load_dwordx4 v6, s[8:11], s27 offen sc1 lds
  s_add_u32 s27, s21, 1024
  s_add_u32 m0, s22, 1024
  s_nop 0
  buffer_load_dwordx4 v6, s[8:11], s27 offen sc1 lds
  s_add_u32 s27, s21, 2048
  s_add_u32 m0, s22, 2048
  s_nop 0
  buffer_load_dwordx4 v6, s[8:11], s27 offen sc1 lds
  s_add_u32 s27, s21, 3072
  s_add_u32 m0, s22, 3072
  s_nop 0
  buffer_load_dwordx4 v6, s[8:11], s27 offen sc1 lds
  s_add_u32 s27, s21, 4096
  s_add_u32 m0, s22, 4096
  s_nop 0
  buffer_load_dwordx4 v6, s[8:11], s27 offen sc1 lds
  s_add_u32 s27, s21, 5120
  s_add_u32 m0, s22, 5120
  s_nop 0
  buffer_load_dwordx4 v6, s[8:11], s27 offen sc1 lds
  s_add_u32 s27, s21, 6144
  s_add_u32 m0, s22, 6144
  s_nop 0
  buffer_load_dwordx4 v6, s[8:11], s27 offen sc1 lds
  s_add_u32 s27, s21, 7168
  s_add_u32 m0, s22, 7168
  s_nop 0
  buffer_load_dwordx4 v6, s[8:11], s27 offen sc1 lds
  s_add_u32 s26, s20, 0
  buffer_load_dwordx4 v[64:67], v1, s[4:7], s26 offen offset:0 sc1
  buffer_load_dwordx4 v[68:71], v1, s[4:7], s26 offen offset:1024 sc1
  s_add_u32 s27, s21, 8192
  s_add_u32 m0, s22, 8192
  s_nop 0
  buffer_load_dwordx4 v6, s[8:11], s27 offen sc1 lds
  buffer_load_dwordx4 v[72:75], v1, s[4:7], s26 offen offset:2048 sc1
  buffer_load_dwordx4 v[76:79], v1, s[4:7], s26 offen offset:3072 sc1
  s_add_u32 s27, s21, 9216
  s_add_u32 m0, s22, 9216
  s_nop 0
  buffer_load_dwordx4 v6, s[8:11], s27 offen sc1 lds
  buffer_load_dwordx4 v[80:83], v2, s[4:7], s26 offen offset:0 sc1
  buffer_load_dwordx4 v[84:87], v2, s[4:7], s26 offen offset:1024 sc1
  s_add_u32 s27, s21, 10240
  s_add_u32 m0, s22, 10240
  s_nop 0
  buffer_load_dwordx4 v6, s[8:11], s27 offen sc1 lds
  buffer_load_dwordx4 v[88:91], v2, s[4:7], s26 offen offset:2048 sc1
  buffer_load_dwordx4 v[92:95], v2, s[4:7], s26 offen offset:3072 sc1
  s_add_u32 s27, s21, 11264
  s_add_u32 m0, s22, 11264
  s_nop 0
  buffer_load_dwordx4 v6, s[8:11], s27 offen sc1 lds
  s_add_u32 s26, s20, 8192
  buffer_load_dwordx4 v[96:99], v1, s[4:7], s26 offen offset:0 sc1
  buffer_load_dwordx4 v[100:103], v1, s[4:7], s26 offen offset:1024 sc1
  s_add_u32 s27, s21, 12288
  s_add_u32 m0, s22, 12288
  s_nop 0
  buffer_load_dwordx4 v6, s[8:11], s27 offen sc1 lds
  buffer_load_dwordx4 v[104:107], v1, s[4:7], s26 offen offset:2048 sc1
  buffer_load_dwordx4 v[108:111], v1, s[4:7], s26 offen offset:3072 sc1
  s_add_u32 s27, s21, 13312
  s_add_u32 m0, s22, 13312
  s_nop 0
  buffer_load_dwordx4 v6, s[8:11], s27 offen sc1 lds
  buffer_load_dwordx4 v[112:115], v2, s[4:7], s26 offen offset:0 sc1
  buffer_load_dwordx4 v[116:119], v2, s[4:7], s26 offen offset:1024 sc1
  s_add_u32 s27, s21, 14336
  s_add_u32 m0, s22, 14336
  s_nop 0
  buffer_load_dwordx4 v6, s[8:11], s27 offen sc1 lds
  buffer_load_dwordx4 v[120:123], v2, s[4:7], s26 offen offset:2048 sc1
  buffer_load_dwordx4 v[124:127], v2, s[4:7], s26 offen offset:3072 sc1
  s_add_u32 s27, s21, 15360
  s_add_u32 m0, s22, 15360
  s_nop 0
  buffer_load_dwordx4 v6, s[8:11], s27 offen sc1 lds
  v_mov_b64 v[128:129], 0
  v_mov_b64 v[130:131], 0
  v_mov_b64 v[132:133], 0
  v_mov_b64 v[134:135], 0
  v_mov_b64 v[136:137], 0
  v_mov_b64 v[138:139], 0
  v_mov_b64 v[140:141], 0
  v_mov_b64 v[142:143], 0
  v_mov_b64 v[144:145], 0
  v_mov_b64 v[146:147], 0
  v_mov_b64 v[148:149], 0
  v_mov_b64 v[150:151], 0
  v_mov_b64 v[152:153], 0
  v_mov_b64 v[154:155], 0
  v_mov_b64 v[156:157], 0
  v_mov_b64 v[158:159], 0
  v_mov_b64 v[160:161], 0
  v_mov_b64 v[162:163], 0
  v_mov_b64 v[164:165], 0
  v_mov_b64 v[166:167], 0
  v_mov_b64 v[168:169], 0
  v_mov_b64 v[170:171], 0
  v_mov_b64 v[172:173], 0
  v_mov_b64 v[174:175], 0
  v_mov_b64 v[176:177], 0
  v_mov_b64 v[178:179], 0
  v_mov_b64 v[180:181], 0
  v_mov_b64 v[182:183], 0
  v_mov_b64 v[184:185], 0
  v_mov_b64 v[186:187], 0
  v_mov_b64 v[188:189], 0
  v_mov_b64 v[190:191], 0
  v_mov_b64 v[192:193], 0
  v_mov_b64 v[194:195], 0
  v_mov_b64 v[196:197], 0
  v_mov_b64 v[198:199], 0
  v_mov_b64 v[200:201], 0
  v_mov_b64 v[202:203], 0
  v_mov_b64 v[204:205], 0
  v_mov_b64 v[206:207], 0
  v_mov_b64 v[208:209], 0
  v_mov_b64 v[210:211], 0
  v_mov_b64 v[212:213], 0
  v_mov_b64 v[214:215], 0
  v_mov_b64 v[216:217], 0
  v_mov_b64 v[218:219], 0
  v_mov_b64 v[220:221], 0
  v_mov_b64 v[222:223], 0
  v_mov_b64 v[224:225], 0
  v_mov_b64 v[226:227], 0
  v_mov_b64 v[228:229], 0
  v_mov_b64 v[230:231], 0
  v_mov_b64 v[232:233], 0
  v_mov_b64 v[234:235], 0
  v_mov_b64 v[236:237], 0
  v_mov_b64 v[238:239], 0
  v_mov_b64 v[240:241], 0
  v_mov_b64 v[242:243], 0
  v_mov_b64 v[244:245], 0
  v_mov_b64 v[246:247], 0
  v_mov_b64 v[248:249], 0
  v_mov_b64 v[250:251], 0
  v_mov_b64 v[252:253], 0
  v_mov_b64 v[254:255], 0
  s_mov_b32 s23, 7
  s_waitcnt vmcnt(28)
  ds_read_b64_tr_b16 v[32:33], v8 offset:0
  ds_read_b64_tr_b16 v[34:35], v8 offset:2048
  ds_read_b64_tr_b16 v[36:37], v9 offset:0
  ds_read_b64_tr_b16 v[38:39], v9 offset:2048
  ds_read_b64_tr_b16 v[40:41], v10 offset:0
  ds_read_b64_tr_b16 v[42:43], v10 offset:2048
  ds_read_b64_tr_b16 v[44:45], v11 offset:0
  ds_read_b64_tr_b16 v[46:47], v11 offset:2048
  s_setprio 0
.p2align 6
down_loop:
  s_waitcnt vmcnt(22) lgkmcnt(0)
  s_add_u32 s26, s20, 16384
  v_mfma_f32_16x16x32_bf16 v[128:131], v[32:35], v[64:67], v[128:131]
  ds_read_b64_tr_b16 v[48:49], v8 offset:4096
  v_mfma_f32_16x16x32_bf16 v[132:135], v[36:39], v[64:67], v[132:135]
  ds_read_b64_tr_b16 v[50:51], v8 offset:6144
  v_mfma_f32_16x16x32_bf16 v[136:139], v[40:43], v[64:67], v[136:139]
  v_mfma_f32_16x16x32_bf16 v[140:143], v[44:47], v[64:67], v[140:143]
  buffer_load_dwordx4 v[64:67], v1, s[4:7], s26 offen offset:0 sc1
  v_mfma_f32_16x16x32_bf16 v[156:159], v[44:47], v[68:71], v[156:159]
  ds_read_b64_tr_b16 v[52:53], v9 offset:4096
  v_mfma_f32_16x16x32_bf16 v[152:155], v[40:43], v[68:71], v[152:155]
  ds_read_b64_tr_b16 v[54:55], v9 offset:6144
  v_mfma_f32_16x16x32_bf16 v[148:151], v[36:39], v[68:71], v[148:151]
  v_mfma_f32_16x16x32_bf16 v[144:147], v[32:35], v[68:71], v[144:147]
  buffer_load_dwordx4 v[68:71], v1, s[4:7], s26 offen offset:1024 sc1
  s_add_u32 s27, s21, 16384
  s_add_u32 m0, s22, 0
  s_nop 0
  buffer_load_dwordx4 v6, s[8:11], s27 offen sc1 lds
  s_waitcnt vmcnt(22)
  v_mfma_f32_16x16x32_bf16 v[160:163], v[32:35], v[72:75], v[160:163]
  ds_read_b64_tr_b16 v[56:57], v10 offset:4096
  v_mfma_f32_16x16x32_bf16 v[164:167], v[36:39], v[72:75], v[164:167]
  ds_read_b64_tr_b16 v[58:59], v10 offset:6144
  v_mfma_f32_16x16x32_bf16 v[168:171], v[40:43], v[72:75], v[168:171]
  v_mfma_f32_16x16x32_bf16 v[172:175], v[44:47], v[72:75], v[172:175]
  buffer_load_dwordx4 v[72:75], v1, s[4:7], s26 offen offset:2048 sc1
  v_mfma_f32_16x16x32_bf16 v[188:191], v[44:47], v[76:79], v[188:191]
  ds_read_b64_tr_b16 v[60:61], v11 offset:4096
  v_mfma_f32_16x16x32_bf16 v[184:187], v[40:43], v[76:79], v[184:187]
  ds_read_b64_tr_b16 v[62:63], v11 offset:6144
  v_mfma_f32_16x16x32_bf16 v[180:183], v[36:39], v[76:79], v[180:183]
  v_mfma_f32_16x16x32_bf16 v[176:179], v[32:35], v[76:79], v[176:179]
  buffer_load_dwordx4 v[76:79], v1, s[4:7], s26 offen offset:3072 sc1
  s_add_u32 s27, s21, 17408
  s_add_u32 m0, s22, 1024
  s_nop 0
  buffer_load_dwordx4 v6, s[8:11], s27 offen sc1 lds
  s_waitcnt vmcnt(22)
  v_mfma_f32_16x16x32_bf16 v[192:195], v[32:35], v[80:83], v[192:195]
  v_mfma_f32_16x16x32_bf16 v[196:199], v[36:39], v[80:83], v[196:199]
  s_cmp_ge_u32 s62, 122880
  s_cbranch_scc1 down_nowo0
  s_mov_b32 m0, s62
  s_add_u32 s62, s62, 4096
  buffer_load_dwordx4 v7, s[16:19], s61 offen sc1 lds
  s_add_u32 s61, s61, 4096
down_nowo0:
  v_mfma_f32_16x16x32_bf16 v[200:203], v[40:43], v[80:83], v[200:203]
  v_mfma_f32_16x16x32_bf16 v[204:207], v[44:47], v[80:83], v[204:207]
  buffer_load_dwordx4 v[80:83], v2, s[4:7], s26 offen offset:0 sc1
  v_mfma_f32_16x16x32_bf16 v[220:223], v[44:47], v[84:87], v[220:223]
  v_mfma_f32_16x16x32_bf16 v[216:219], v[40:43], v[84:87], v[216:219]
  v_mfma_f32_16x16x32_bf16 v[212:215], v[36:39], v[84:87], v[212:215]
  v_mfma_f32_16x16x32_bf16 v[208:211], v[32:35], v[84:87], v[208:211]
  buffer_load_dwordx4 v[84:87], v2, s[4:7], s26 offen offset:1024 sc1
  s_add_u32 s27, s21, 18432
  s_add_u32 m0, s22, 2048
  s_nop 0
  buffer_load_dwordx4 v6, s[8:11], s27 offen sc1 lds
  s_waitcnt vmcnt(22)
  v_mfma_f32_16x16x32_bf16 v[224:227], v[32:35], v[88:91], v[224:227]
  v_mfma_f32_16x16x32_bf16 v[228:231], v[36:39], v[88:91], v[228:231]
  v_mfma_f32_16x16x32_bf16 v[232:235], v[40:43], v[88:91], v[232:235]
  v_mfma_f32_16x16x32_bf16 v[236:239], v[44:47], v[88:91], v[236:239]
  buffer_load_dwordx4 v[88:91], v2, s[4:7], s26 offen offset:2048 sc1
  v_mfma_f32_16x16x32_bf16 v[252:255], v[44:47], v[92:95], v[252:255]
  v_mfma_f32_16x16x32_bf16 v[248:251], v[40:43], v[92:95], v[248:251]
  v_mfma_f32_16x16x32_bf16 v[244:247], v[36:39], v[92:95], v[244:247]
  v_mfma_f32_16x16x32_bf16 v[240:243], v[32:35], v[92:95], v[240:243]
  buffer_load_dwordx4 v[92:95], v2, s[4:7], s26 offen offset:3072 sc1
  s_add_u32 s27, s21, 19456
  s_add_u32 m0, s22, 3072
  s_nop 0
  buffer_load_dwordx4 v6, s[8:11], s27 offen sc1 lds
  s_waitcnt vmcnt(22) lgkmcnt(0)
  s_add_u32 s26, s20, 24576
  v_mfma_f32_16x16x32_bf16 v[128:131], v[48:51], v[96:99], v[128:131]
  ds_read_b64_tr_b16 v[32:33], v8 offset:8192
  v_mfma_f32_16x16x32_bf16 v[132:135], v[52:55], v[96:99], v[132:135]
  ds_read_b64_tr_b16 v[34:35], v8 offset:10240
  v_mfma_f32_16x16x32_bf16 v[136:139], v[56:59], v[96:99], v[136:139]
  v_mfma_f32_16x16x32_bf16 v[140:143], v[60:63], v[96:99], v[140:143]
  buffer_load_dwordx4 v[96:99], v1, s[4:7], s26 offen offset:0 sc1
  v_mfma_f32_16x16x32_bf16 v[156:159], v[60:63], v[100:103], v[156:159]
  ds_read_b64_tr_b16 v[36:37], v9 offset:8192
  v_mfma_f32_16x16x32_bf16 v[152:155], v[56:59], v[100:103], v[152:155]
  ds_read_b64_tr_b16 v[38:39], v9 offset:10240
  v_mfma_f32_16x16x32_bf16 v[148:151], v[52:55], v[100:103], v[148:151]
  v_mfma_f32_16x16x32_bf16 v[144:147], v[48:51], v[100:103], v[144:147]
  buffer_load_dwordx4 v[100:103], v1, s[4:7], s26 offen offset:1024 sc1
  s_add_u32 s27, s21, 20480
  s_add_u32 m0, s22, 4096
  s_nop 0
  buffer_load_dwordx4 v6, s[8:11], s27 offen sc1 lds
  s_waitcnt vmcnt(22)
  v_mfma_f32_16x16x32_bf16 v[160:163], v[48:51], v[104:107], v[160:163]
  ds_read_b64_tr_b16 v[40:41], v10 offset:8192
  v_mfma_f32_16x16x32_bf16 v[164:167], v[52:55], v[104:107], v[164:167]
  ds_read_b64_tr_b16 v[42:43], v10 offset:10240
  v_mfma_f32_16x16x32_bf16 v[168:171], v[56:59], v[104:107], v[168:171]
  v_mfma_f32_16x16x32_bf16 v[172:175], v[60:63], v[104:107], v[172:175]
  buffer_load_dwordx4 v[104:107], v1, s[4:7], s26 offen offset:2048 sc1
  v_mfma_f32_16x16x32_bf16 v[188:191], v[60:63], v[108:111], v[188:191]
  ds_read_b64_tr_b16 v[44:45], v11 offset:8192
  v_mfma_f32_16x16x32_bf16 v[184:187], v[56:59], v[108:111], v[184:187]
  ds_read_b64_tr_b16 v[46:47], v11 offset:10240
  v_mfma_f32_16x16x32_bf16 v[180:183], v[52:55], v[108:111], v[180:183]
  v_mfma_f32_16x16x32_bf16 v[176:179], v[48:51], v[108:111], v[176:179]
  buffer_load_dwordx4 v[108:111], v1, s[4:7], s26 offen offset:3072 sc1
  s_add_u32 s27, s21, 21504
  s_add_u32 m0, s22, 5120
  s_nop 0
  buffer_load_dwordx4 v6, s[8:11], s27 offen sc1 lds
  s_waitcnt vmcnt(22)
  v_mfma_f32_16x16x32_bf16 v[192:195], v[48:51], v[112:115], v[192:195]
  v_mfma_f32_16x16x32_bf16 v[196:199], v[52:55], v[112:115], v[196:199]
  s_cmp_ge_u32 s62, 122880
  s_cbranch_scc1 down_nowo1
  s_mov_b32 m0, s62
  s_add_u32 s62, s62, 4096
  buffer_load_dwordx4 v7, s[16:19], s61 offen sc1 lds
  s_add_u32 s61, s61, 4096
down_nowo1:
  v_mfma_f32_16x16x32_bf16 v[200:203], v[56:59], v[112:115], v[200:203]
  v_mfma_f32_16x16x32_bf16 v[204:207], v[60:63], v[112:115], v[204:207]
  buffer_load_dwordx4 v[112:115], v2, s[4:7], s26 offen offset:0 sc1
  v_mfma_f32_16x16x32_bf16 v[220:223], v[60:63], v[116:119], v[220:223]
  v_mfma_f32_16x16x32_bf16 v[216:219], v[56:59], v[116:119], v[216:219]
  v_mfma_f32_16x16x32_bf16 v[212:215], v[52:55], v[116:119], v[212:215]
  v_mfma_f32_16x16x32_bf16 v[208:211], v[48:51], v[116:119], v[208:211]
  buffer_load_dwordx4 v[116:119], v2, s[4:7], s26 offen offset:1024 sc1
  s_add_u32 s27, s21, 22528
  s_add_u32 m0, s22, 6144
  s_nop 0
  buffer_load_dwordx4 v6, s[8:11], s27 offen sc1 lds
  s_waitcnt vmcnt(22)
  v_mfma_f32_16x16x32_bf16 v[224:227], v[48:51], v[120:123], v[224:227]
  v_mfma_f32_16x16x32_bf16 v[228:231], v[52:55], v[120:123], v[228:231]
  v_mfma_f32_16x16x32_bf16 v[232:235], v[56:59], v[120:123], v[232:235]
  v_mfma_f32_16x16x32_bf16 v[236:239], v[60:63], v[120:123], v[236:239]
  buffer_load_dwordx4 v[120:123], v2, s[4:7], s26 offen offset:2048 sc1
  v_mfma_f32_16x16x32_bf16 v[252:255], v[60:63], v[124:127], v[252:255]
  v_mfma_f32_16x16x32_bf16 v[248:251], v[56:59], v[124:127], v[248:251]
  v_mfma_f32_16x16x32_bf16 v[244:247], v[52:55], v[124:127], v[244:247]
  v_mfma_f32_16x16x32_bf16 v[240:243], v[48:51], v[124:127], v[240:243]
  buffer_load_dwordx4 v[124:127], v2, s[4:7], s26 offen offset:3072 sc1
  s_add_u32 s27, s21, 23552
  s_add_u32 m0, s22, 7168
  s_nop 0
  buffer_load_dwordx4 v6, s[8:11], s27 offen sc1 lds
  s_cmp_eq_u32 s23, 1
  s_cselect_b32 s6, 0, s6
  s_waitcnt vmcnt(22) lgkmcnt(0)
  s_add_u32 s26, s20, 32768
  v_mfma_f32_16x16x32_bf16 v[128:131], v[32:35], v[64:67], v[128:131]
  ds_read_b64_tr_b16 v[48:49], v8 offset:12288
  v_mfma_f32_16x16x32_bf16 v[132:135], v[36:39], v[64:67], v[132:135]
  ds_read_b64_tr_b16 v[50:51], v8 offset:14336
  v_mfma_f32_16x16x32_bf16 v[136:139], v[40:43], v[64:67], v[136:139]
  v_mfma_f32_16x16x32_bf16 v[140:143], v[44:47], v[64:67], v[140:143]
  buffer_load_dwordx4 v[64:67], v1, s[4:7], s26 offen offset:0 sc1
  v_mfma_f32_16x16x32_bf16 v[156:159], v[44:47], v[68:71], v[156:159]
  ds_read_b64_tr_b16 v[52:53], v9 offset:12288
  v_mfma_f32_16x16x32_bf16 v[152:155], v[40:43], v[68:71], v[152:155]
  ds_read_b64_tr_b16 v[54:55], v9 offset:14336
  v_mfma_f32_16x16x32_bf16 v[148:151], v[36:39], v[68:71], v[148:151]
  v_mfma_f32_16x16x32_bf16 v[144:147], v[32:35], v[68:71], v[144:147]
  buffer_load_dwordx4 v[68:71], v1, s[4:7], s26 offen offset:1024 sc1
  s_add_u32 s27, s21, 24576
  s_add_u32 m0, s22, 8192
  s_nop 0
  buffer_load_dwordx4 v6, s[8:11], s27 offen sc1 lds
  s_waitcnt vmcnt(22)
  v_mfma_f32_16x16x32_bf16 v[160:163], v[32:35], v[72:75], v[160:163]
  ds_read_b64_tr_b16 v[56:57], v10 offset:12288
  v_mfma_f32_16x16x32_bf16 v[164:167], v[36:39], v[72:75], v[164:167]
  ds_read_b64_tr_b16 v[58:59], v10 offset:14336
  v_mfma_f32_16x16x32_bf16 v[168:171], v[40:43], v[72:75], v[168:171]
  v_mfma_f32_16x16x32_bf16 v[172:175], v[44:47], v[72:75], v[172:175]
  buffer_load_dwordx4 v[72:75], v1, s[4:7], s26 offen offset:2048 sc1
  v_mfma_f32_16x16x32_bf16 v[188:191], v[44:47], v[76:79], v[188:191]
  ds_read_b64_tr_b16 v[60:61], v11 offset:12288
  v_mfma_f32_16x16x32_bf16 v[184:187], v[40:43], v[76:79], v[184:187]
  ds_read_b64_tr_b16 v[62:63], v11 offset:14336
  v_mfma_f32_16x16x32_bf16 v[180:183], v[36:39], v[76:79], v[180:183]
  v_mfma_f32_16x16x32_bf16 v[176:179], v[32:35], v[76:79], v[176:179]
  buffer_load_dwordx4 v[76:79], v1, s[4:7], s26 offen offset:3072 sc1
  s_add_u32 s27, s21, 25600
  s_add_u32 m0, s22, 9216
  s_nop 0
  buffer_load_dwordx4 v6, s[8:11], s27 offen sc1 lds
  s_waitcnt vmcnt(22)
  v_mfma_f32_16x16x32_bf16 v[192:195], v[32:35], v[80:83], v[192:195]
  v_mfma_f32_16x16x32_bf16 v[196:199], v[36:39], v[80:83], v[196:199]
  s_cmp_ge_u32 s62, 122880
  s_cbranch_scc1 down_nowo2
  s_mov_b32 m0, s62
  s_add_u32 s62, s62, 4096
  buffer_load_dwordx4 v7, s[16:19], s61 offen sc1 lds
  s_add_u32 s61, s61, 4096
down_nowo2:
  v_mfma_f32_16x16x32_bf16 v[200:203], v[40:43], v[80:83], v[200:203]
  v_mfma_f32_16x16x32_bf16 v[204:207], v[44:47], v[80:83], v[204:207]
  buffer_load_dwordx4 v[80:83], v2, s[4:7], s26 offen offset:0 sc1
  v_mfma_f32_16x16x32_bf16 v[220:223], v[44:47], v[84:87], v[220:223]
  v_mfma_f32_16x16x32_bf16 v[216:219], v[40:43], v[84:87], v[216:219]
  v_mfma_f32_16x16x32_bf16 v[212:215], v[36:39], v[84:87], v[212:215]
  v_mfma_f32_16x16x32_bf16 v[208:211], v[32:35], v[84:87], v[208:211]
  buffer_load_dwordx4 v[84:87], v2, s[4:7], s26 offen offset:1024 sc1
  s_add_u32 s27, s21, 26624
  s_add_u32 m0, s22, 10240
  s_nop 0
  buffer_load_dwordx4 v6, s[8:11], s27 offen sc1 lds
  s_waitcnt vmcnt(22)
  v_mfma_f32_16x16x32_bf16 v[224:227], v[32:35], v[88:91], v[224:227]
  v_mfma_f32_16x16x32_bf16 v[228:231], v[36:39], v[88:91], v[228:231]
  v_mfma_f32_16x16x32_bf16 v[232:235], v[40:43], v[88:91], v[232:235]
  v_mfma_f32_16x16x32_bf16 v[236:239], v[44:47], v[88:91], v[236:239]
  buffer_load_dwordx4 v[88:91], v2, s[4:7], s26 offen offset:2048 sc1
  v_mfma_f32_16x16x32_bf16 v[252:255], v[44:47], v[92:95], v[252:255]
  v_mfma_f32_16x16x32_bf16 v[248:251], v[40:43], v[92:95], v[248:251]
  v_mfma_f32_16x16x32_bf16 v[244:247], v[36:39], v[92:95], v[244:247]
  v_mfma_f32_16x16x32_bf16 v[240:243], v[32:35], v[92:95], v[240:243]
  buffer_load_dwordx4 v[92:95], v2, s[4:7], s26 offen offset:3072 sc1
  s_add_u32 s27, s21, 27648
  s_add_u32 m0, s22, 11264
  s_nop 0
  buffer_load_dwordx4 v6, s[8:11], s27 offen sc1 lds
  s_waitcnt vmcnt(22) lgkmcnt(0)
  s_add_u32 s26, s20, 40960
  v_mfma_f32_16x16x32_bf16 v[128:131], v[48:51], v[96:99], v[128:131]
  ds_read_b64_tr_b16 v[32:33], v8 offset:0
  v_mfma_f32_16x16x32_bf16 v[132:135], v[52:55], v[96:99], v[132:135]
  ds_read_b64_tr_b16 v[34:35], v8 offset:2048
  v_mfma_f32_16x16x32_bf16 v[136:139], v[56:59], v[96:99], v[136:139]
  v_mfma_f32_16x16x32_bf16 v[140:143], v[60:63], v[96:99], v[140:143]
  buffer_load_dwordx4 v[96:99], v1, s[4:7], s26 offen offset:0 sc1
  v_mfma_f32_16x16x32_bf16 v[156:159], v[60:63], v[100:103], v[156:159]
  ds_read_b64_tr_b16 v[36:37], v9 offset:0
  v_mfma_f32_16x16x32_bf16 v[152:155], v[56:59], v[100:103], v[152:155]
  ds_read_b64_tr_b16 v[38:39], v9 offset:2048
  v_mfma_f32_16x16x32_bf16 v[148:151], v[52:55], v[100:103], v[148:151]
  v_mfma_f32_16x16x32_bf16 v[144:147], v[48:51], v[100:103], v[144:147]
  buffer_load_dwordx4 v[100:103], v1, s[4:7], s26 offen offset:1024 sc1
  s_add_u32 s27, s21, 28672
  s_add_u32 m0, s22, 12288
  s_nop 0
  buffer_load_dwordx4 v6, s[8:11], s27 offen sc1 lds
  s_waitcnt vmcnt(22)
  v_mfma_f32_16x16x32_bf16 v[160:163], v[48:51], v[104:107], v[160:163]
  ds_read_b64_tr_b16 v[40:41], v10 offset:0
  v_mfma_f32_16x16x32_bf16 v[164:167], v[52:55], v[104:107], v[164:167]
  ds_read_b64_tr_b16 v[42:43], v10 offset:2048
  v_mfma_f32_16x16x32_bf16 v[168:171], v[56:59], v[104:107], v[168:171]
  v_mfma_f32_16x16x32_bf16 v[172:175], v[60:63], v[104:107], v[172:175]
  buffer_load_dwordx4 v[104:107], v1, s[4:7], s26 offen offset:2048 sc1
  v_mfma_f32_16x16x32_bf16 v[188:191], v[60:63], v[108:111], v[188:191]
  ds_read_b64_tr_b16 v[44:45], v11 offset:0
  v_mfma_f32_16x16x32_bf16 v[184:187], v[56:59], v[108:111], v[184:187]
  ds_read_b64_tr_b16 v[46:47], v11 offset:2048
  v_mfma_f32_16x16x32_bf16 v[180:183], v[52:55], v[108:111], v[180:183]
  v_mfma_f32_16x16x32_bf16 v[176:179], v[48:51], v[108:111], v[176:179]
  buffer_load_dwordx4 v[108:111], v1, s[4:7], s26 offen offset:3072 sc1
  s_add_u32 s27, s21, 29696
  s_add_u32 m0, s22, 13312
  s_nop 0
  buffer_load_dwordx4 v6, s[8:11], s27 offen sc1 lds
  s_waitcnt vmcnt(22)
  v_mfma_f32_16x16x32_bf16 v[192:195], v[48:51], v[112:115], v[192:195]
  v_mfma_f32_16x16x32_bf16 v[196:199], v[52:55], v[112:115], v[196:199]
  s_cmp_lg_u32 s23, 2
  s_cbranch_scc1 down_nofl
  ds_write_b32 v4, v5
down_nofl:
  v_mfma_f32_16x16x32_bf16 v[200:203], v[56:59], v[112:115], v[200:203]
  v_mfma_f32_16x16x32_bf16 v[204:207], v[60:63], v[112:115], v[204:207]
  buffer_load_dwordx4 v[112:115], v2, s[4:7], s26 offen offset:0 sc1
  v_mfma_f32_16x16x32_bf16 v[220:223], v[60:63], v[116:119], v[220:223]
  v_mfma_f32_16x16x32_bf16 v[216:219], v[56:59], v[116:119], v[216:219]
  v_mfma_f32_16x16x32_bf16 v[212:215], v[52:55], v[116:119], v[212:215]
  v_mfma_f32_16x16x32_bf16 v[208:211], v[48:51], v[116:119], v[208:211]
  buffer_load_dwordx4 v[116:119], v2, s[4:7], s26 offen offset:1024 sc1
  s_add_u32 s27, s21, 30720
  s_add_u32 m0, s22, 14336
  s_nop 0
  buffer_load_dwordx4 v6, s[8:11], s27 offen sc1 lds
  s_waitcnt vmcnt(22)
  v_mfma_f32_16x16x32_bf16 v[224:227], v[48:51], v[120:123], v[224:227]
  v_mfma_f32_16x16x32_bf16 v[228:231], v[52:55], v[120:123], v[228:231]
  v_mfma_f32_16x16x32_bf16 v[232:235], v[56:59], v[120:123], v[232:235]
  v_mfma_f32_16x16x32_bf16 v[236:239], v[60:63], v[120:123], v[236:239]
  buffer_load_dwordx4 v[120:123], v2, s[4:7], s26 offen offset:2048 sc1
  v_mfma_f32_16x16x32_bf16 v[252:255], v[60:63], v[124:127], v[252:255]
  v_mfma_f32_16x16x32_bf16 v[248:251], v[56:59], v[124:127], v[248:251]
  v_mfma_f32_16x16x32_bf16 v[244:247], v[52:55], v[124:127], v[244:247]
  v_mfma_f32_16x16x32_bf16 v[240:243], v[48:51], v[124:127], v[240:243]
  buffer_load_dwordx4 v[124:127], v2, s[4:7], s26 offen offset:3072 sc1
  s_add_u32 s27, s21, 31744
  s_add_u32 m0, s22, 15360
  s_nop 0
  buffer_load_dwordx4 v6, s[8:11], s27 offen sc1 lds
  s_add_u32 s20, s20, 32768
  s_add_u32 s21, s21, 16384
  s_sub_u32 s23, s23, 1
  s_cmp_lg_u32 s23, 0
  s_cbranch_scc1 down_loop
  s_setprio 2
  s_waitcnt vmcnt(0) lgkmcnt(0)
  v_add_u32 v12, s22, v1
  v_xor_b32 v13, 0x8000, v12
  v_xor_b32 v14, 0xc000, v12
  s_lshl_b32 s27, s24, 2
  s_add_u32 s27, s27, 163344
  v_mov_b32 v3, s27
  v_xor_b32 v4, 8, v3
  v_xor_b32 v15, 4, v3
  v_mov_b32 v5, 1
  s_cmp_ge_u32 s24, 2
  s_cbranch_scc1 red1_hi
  ds_write_b128 v12, v[192:195] offset:0
  ds_write_b128 v12, v[196:199] offset:1024
  ds_write_b128 v12, v[200:203] offset:2048
  ds_write_b128 v12, v[204:207] offset:3072
  ds_write_b128 v12, v[208:211] offset:4096
  ds_write_b128 v12, v[212:215] offset:5120
  ds_write_b128 v12, v[216:219] offset:6144
  ds_write_b128 v12, v[220:223] offset:7168
  ds_write_b128 v12, v[224:227] offset:8192
  ds_write_b128 v12, v[228:231] offset:9216
  ds_write_b128 v12, v[232:235] offset:10240
  ds_write_b128 v12, v[236:239] offset:11264
  ds_write_b128 v12, v[240:243] offset:12288
  ds_write_b128 v12, v[244:247] offset:13312
  ds_write_b128 v12, v[248:251] offset:14336
  ds_write_b128 v12, v[252:255] offset:15360
  s_branch red1_w
red1_hi:
  ds_write_b128 v12, v[128:131] offset:0
  ds_write_b128 v12, v[132:135] offset:1024
  ds_write_b128 v12, v[136:139] offset:2048
  ds_write_b128 v12, v[140:143] offset:3072
  ds_write_b128 v12, v[144:147] offset:4096
  ds_write_b128 v12, v[148:151] offset:5120
  ds_write_b128 v12, v[152:155] offset:6144
  ds_write_b128 v12, v[156:159] offset:7168
  ds_write_b128 v12, v[160:163] offset:8192
  ds_write_b128 v12, v[164:167] offset:9216
  ds_write_b128 v12, v[168:171] offset:10240
  ds_write_b128 v12, v[172:175] offset:11264
  ds_write_b128 v12, v[176:179] offset:12288
  ds_write_b128 v12, v[180:183] offset:13312
  ds_write_b128 v12, v[184:187] offset:14336
  ds_write_b128 v12, v[188:191] offset:15360
red1_w:
  s_waitcnt lgkmcnt(0)
  ds_write_b32 v3, v5
  s_mov_b32 s27, 8388608
red_a_poll:
  ds_read_b32 v16, v4 offset:0
  s_waitcnt lgkmcnt(0)
  v_cmp_ne_u32 vcc, 1, v16
  s_cbranch_vccz red_a_ok
  s_sleep 1
  s_sub_u32 s27, s27, 1
  s_cmp_lg_u32 s27, 0
  s_cbranch_scc1 red_a_poll
red_a_ok:
  ds_read_b128 v[64:67], v13 offset:0
  ds_read_b128 v[68:71], v13 offset:1024
  ds_read_b128 v[72:75], v13 offset:2048
  ds_read_b128 v[76:79], v13 offset:3072
  ds_read_b128 v[80:83], v13 offset:4096
  ds_read_b128 v[84:87], v13 offset:5120
  ds_read_b128 v[88:91], v13 offset:6144
  ds_read_b128 v[92:95], v13 offset:7168
  ds_read_b128 v[96:99], v13 offset:8192
  ds_read_b128 v[100:103], v13 offset:9216
  ds_read_b128 v[104:107], v13 offset:10240
  ds_read_b128 v[108:111], v13 offset:11264
  ds_read_b128 v[112:115], v13 offset:12288
  ds_read_b128 v[116:119], v13 offset:13312
  ds_read_b128 v[120:123], v13 offset:14336
  s_waitcnt lgkmcnt(7)
  ds_read_b128 v[124:127], v13 offset:15360
  s_cmp_ge_u32 s24, 2
  s_cbranch_scc1 red1a_hi
  v_add_f32 v64, v64, v128
  v_add_f32 v65, v65, v129
  v_add_f32 v66, v66, v130
  v_add_f32 v67, v67, v131
  v_add_f32 v68, v68, v132
  v_add_f32 v69, v69, v133
  v_add_f32 v70, v70, v134
  v_add_f32 v71, v71, v135
  v_add_f32 v72, v72, v136
  v_add_f32 v73, v73, v137
  v_add_f32 v74, v74, v138
  v_add_f32 v75, v75, v139
  v_add_f32 v76, v76, v140
  v_add_f32 v77, v77, v141
  v_add_f32 v78, v78, v142
  v_add_f32 v79, v79, v143
  v_add_f32 v80, v80, v144
  v_add_f32 v81, v81, v145
  v_add_f32 v82, v82, v146
  v_add_f32 v83, v83, v147
  v_add_f32 v84, v84, v148
  v_add_f32 v85, v85, v149
  v_add_f32 v86, v86, v150
  v_add_f32 v87, v87, v151
  v_add_f32 v88, v88, v152
  v_add_f32 v89, v89, v153
  v_add_f32 v90, v90, v154
  v_add_f32 v91, v91, v155
  v_add_f32 v92, v92, v156
  v_add_f32 v93, v93, v157
  v_add_f32 v94, v94, v158
  v_add_f32 v95, v95, v159
  s_waitcnt lgkmcnt(0)
  v_add_f32 v96, v96, v160
  v_add_f32 v97, v97, v161
  v_add_f32 v98, v98, v162
  v_add_f32 v99, v99, v163
  v_add_f32 v100, v100, v164
  v_add_f32 v101, v101, v165
  v_add_f32 v102, v102, v166
  v_add_f32 v103, v103, v167
  v_add_f32 v104, v104, v168
  v_add_f32 v105, v105, v169
  v_add_f32 v106, v106, v170
  v_add_f32 v107, v107, v171
  v_add_f32 v108, v108, v172
  v_add_f32 v109, v109, v173
  v_add_f32 v110, v110, v174
  v_add_f32 v111, v111, v175
  v_add_f32 v112, v112, v176
  v_add_f32 v113, v113, v177
  v_add_f32 v114, v114, v178
  v_add_f32 v115, v115, v179
  v_add_f32 v116, v116, v180
  v_add_f32 v117, v117, v181
  v_add_f32 v118, v118, v182
  v_add_f32 v119, v119, v183
  v_add_f32 v120, v120, v184
  v_add_f32 v121, v121, v185
  v_add_f32 v122, v122, v186
  v_add_f32 v123, v123, v187
  v_add_f32 v124, v124, v188
  v_add_f32 v125, v125, v189
  v_add_f32 v126, v126, v190
  v_add_f32 v127, v127, v191
  s_branch red1a_d
red1a_hi:
  v_add_f32 v64, v64, v192
  v_add_f32 v65, v65, v193
  v_add_f32 v66, v66, v194
  v_add_f32 v67, v67, v195
  v_add_f32 v68, v68, v196
  v_add_f32 v69, v69, v197
  v_add_f32 v70, v70, v198
  v_add_f32 v71, v71, v199
  v_add_f32 v72, v72, v200
  v_add_f32 v73, v73, v201
  v_add_f32 v74, v74, v202
  v_add_f32 v75, v75, v203
  v_add_f32 v76, v76, v204
  v_add_f32 v77, v77, v205
  v_add_f32 v78, v78, v206
  v_add_f32 v79, v79, v207
  v_add_f32 v80, v80, v208
  v_add_f32 v81, v81, v209
  v_add_f32 v82, v82, v210
  v_add_f32 v83, v83, v211
  v_add_f32 v84, v84, v212
  v_add_f32 v85, v85, v213
  v_add_f32 v86, v86, v214
  v_add_f32 v87, v87, v215
  v_add_f32 v88, v88, v216
  v_add_f32 v89, v89, v217
  v_add_f32 v90, v90, v218
  v_add_f32 v91, v91, v219
  v_add_f32 v92, v92, v220
  v_add_f32 v93, v93, v221
  v_add_f32 v94, v94, v222
  v_add_f32 v95, v95, v223
  s_waitcnt lgkmcnt(0)
  v_add_f32 v96, v96, v224
  v_add_f32 v97, v97, v225
  v_add_f32 v98, v98, v226
  v_add_f32 v99, v99, v227
  v_add_f32 v100, v100, v228
  v_add_f32 v101, v101, v229
  v_add_f32 v102, v102, v230
  v_add_f32 v103, v103, v231
  v_add_f32 v104, v104, v232
  v_add_f32 v105, v105, v233
  v_add_f32 v106, v106, v234
  v_add_f32 v107, v107, v235
  v_add_f32 v108, v108, v236
  v_add_f32 v109, v109, v237
  v_add_f32 v110, v110, v238
  v_add_f32 v111, v111, v239
  v_add_f32 v112, v112, v240
  v_add_f32 v113, v113, v241
  v_add_f32 v114, v114, v242
  v_add_f32 v115, v115, v243
  v_add_f32 v116, v116, v244
  v_add_f32 v117, v117, v245
  v_add_f32 v118, v118, v246
  v_add_f32 v119, v119, v247
  v_add_f32 v120, v120, v248
  v_add_f32 v121, v121, v249
  v_add_f32 v122, v122, v250
  v_add_f32 v123, v123, v251
  v_add_f32 v124, v124, v252
  v_add_f32 v125, v125, v253
  v_add_f32 v126, v126, v254
  v_add_f32 v127, v127, v255
red1a_d:
  s_bitcmp1_b32 s24, 0
  s_cbranch_scc1 red2_hi
  ds_write_b128 v13, v[96:99] offset:0
  ds_write_b128 v13, v[100:103] offset:1024
  ds_write_b128 v13, v[104:107] offset:2048
  ds_write_b128 v13, v[108:111] offset:3072
  ds_write_b128 v13, v[112:115] offset:4096
  ds_write_b128 v13, v[116:119] offset:5120
  ds_write_b128 v13, v[120:123] offset:6144
  ds_write_b128 v13, v[124:127] offset:7168
  s_branch red2_w
red2_hi:
  ds_write_b128 v13, v[64:67] offset:0
  ds_write_b128 v13, v[68:71] offset:1024
  ds_write_b128 v13, v[72:75] offset:2048
  ds_write_b128 v13, v[76:79] offset:3072
  ds_write_b128 v13, v[80:83] offset:4096
  ds_write_b128 v13, v[84:87] offset:5120
  ds_write_b128 v13, v[88:91] offset:6144
  ds_write_b128 v13, v[92:95] offset:7168
  s_waitcnt lgkmcnt(0)
  v_mov_b64 v[64:65], v[96:97]
  v_mov_b64 v[66:67], v[98:99]
  v_mov_b64 v[68:69], v[100:101]
  v_mov_b64 v[70:71], v[102:103]
  v_mov_b64 v[72:73], v[104:105]
  v_mov_b64 v[74:75], v[106:107]
  v_mov_b64 v[76:77], v[108:109]
  v_mov_b64 v[78:79], v[110:111]
  v_mov_b64 v[80:81], v[112:113]
  v_mov_b64 v[82:83], v[114:115]
  v_mov_b64 v[84:85], v[116:117]
  v_mov_b64 v[86:87], v[118:119]
  v_mov_b64 v[88:89], v[120:121]
  v_mov_b64 v[90:91], v[122:123]
  v_mov_b64 v[92:93], v[124:125]
  v_mov_b64 v[94:95], v[126:127]
red2_w:
  s_waitcnt lgkmcnt(0)
  ds_write_b32 v3, v5 offset:16
  s_mov_b32 s27, 8388608
red_b_poll:
  ds_read_b32 v16, v15 offset:16
  s_waitcnt lgkmcnt(0)
  v_cmp_ne_u32 vcc, 1, v16
  s_cbranch_vccz red_b_ok
  s_sleep 1
  s_sub_u32 s27, s27, 1
  s_cmp_lg_u32 s27, 0
  s_cbranch_scc1 red_b_poll
red_b_ok:
  ds_read_b128 v[16:19], v14 offset:0
  ds_read_b128 v[20:23], v14 offset:1024
  ds_read_b128 v[24:27], v14 offset:2048
  ds_read_b128 v[28:31], v14 offset:3072
  ds_read_b128 v[32:35], v14 offset:4096
  ds_read_b128 v[36:39], v14 offset:5120
  ds_read_b128 v[40:43], v14 offset:6144
  ds_read_b128 v[44:47], v14 offset:7168
  s_waitcnt lgkmcnt(0)
  v_add_f32 v16, v16, v64
  v_add_f32 v17, v17, v65
  v_add_f32 v18, v18, v66
  v_add_f32 v19, v19, v67
  v_add_f32 v20, v20, v68
  v_add_f32 v21, v21, v69
  v_add_f32 v22, v22, v70
  v_add_f32 v23, v23, v71
  v_add_f32 v24, v24, v72
  v_add_f32 v25, v25, v73
  v_add_f32 v26, v26, v74
  v_add_f32 v27, v27, v75
  v_add_f32 v28, v28, v76
  v_add_f32 v29, v29, v77
  v_add_f32 v30, v30, v78
  v_add_f32 v31, v31, v79
  v_add_f32 v32, v32, v80
  v_add_f32 v33, v33, v81
  v_add_f32 v34, v34, v82
  v_add_f32 v35, v35, v83
  v_add_f32 v36, v36, v84
  v_add_f32 v37, v37, v85
  v_add_f32 v38, v38, v86
  v_add_f32 v39, v39, v87
  v_add_f32 v40, v40, v88
  v_add_f32 v41, v41, v89
  v_add_f32 v42, v42, v90
  v_add_f32 v43, v43, v91
  v_add_f32 v44, v44, v92
  v_add_f32 v45, v45, v93
  v_add_f32 v46, v46, v94
  v_add_f32 v47, v47, v95
  s_mov_b32 s32, 0xffff0000
  s_mov_b32 s33, 0xbfb8aa3b
  v_cvt_pk_bf16_f32 v64, v16, v17
  v_cvt_pk_bf16_f32 v65, v18, v19
  v_cvt_pk_bf16_f32 v66, v20, v21
  v_cvt_pk_bf16_f32 v67, v22, v23
  v_cvt_pk_bf16_f32 v68, v24, v25
  v_cvt_pk_bf16_f32 v69, v26, v27
  v_cvt_pk_bf16_f32 v70, v28, v29
  v_cvt_pk_bf16_f32 v71, v30, v31
  v_cvt_pk_bf16_f32 v72, v32, v33
  v_cvt_pk_bf16_f32 v73, v34, v35
  v_cvt_pk_bf16_f32 v74, v36, v37
  v_cvt_pk_bf16_f32 v75, v38, v39
  v_cvt_pk_bf16_f32 v76, v40, v41
  v_cvt_pk_bf16_f32 v77, v42, v43
  v_cvt_pk_bf16_f32 v78, v44, v45
  v_cvt_pk_bf16_f32 v79, v46, v47
  v_lshlrev_b32 v16, 16, v64
  v_and_b32 v17, s32, v64
  v_lshlrev_b32 v18, 16, v65
  v_and_b32 v19, s32, v65
  v_lshlrev_b32 v20, 16, v66
  v_and_b32 v21, s32, v66
  v_lshlrev_b32 v22, 16, v67
  v_and_b32 v23, s32, v67
  v_lshlrev_b32 v24, 16, v68
  v_and_b32 v25, s32, v68
  v_lshlrev_b32 v26, 16, v69
  v_and_b32 v27, s32, v69
  v_lshlrev_b32 v28, 16, v70
  v_and_b32 v29, s32, v70
  v_lshlrev_b32 v30, 16, v71
  v_and_b32 v31, s32, v71
  v_lshlrev_b32 v32, 16, v72
  v_and_b32 v33, s32, v72
  v_lshlrev_b32 v34, 16, v73
  v_and_b32 v35, s32, v73
  v_lshlrev_b32 v36, 16, v74
  v_and_b32 v37, s32, v74
  v_lshlrev_b32 v38, 16, v75
  v_and_b32 v39, s32, v75
  v_lshlrev_b32 v40, 16, v76
  v_and_b32 v41, s32, v76
  v_lshlrev_b32 v42, 16, v77
  v_and_b32 v43, s32, v77
  v_lshlrev_b32 v44, 16, v78
  v_and_b32 v45, s32, v78
  v_lshlrev_b32 v46, 16, v79
  v_and_b32 v47, s32, v79
  v_mul_f32 v64, s33, v16
  v_mul_f32 v65, s33, v17
  v_mul_f32 v66, s33, v18
  v_mul_f32 v67, s33, v19
  v_mul_f32 v68, s33, v20
  v_mul_f32 v69, s33, v21
  v_mul_f32 v70, s33, v22
  v_mul_f32 v71, s33, v23
  v_mul_f32 v72, s33, v24
  v_mul_f32 v73, s33, v25
  v_mul_f32 v74, s33, v26
  v_mul_f32 v75, s33, v27
  v_mul_f32 v76, s33, v28
  v_mul_f32 v77, s33, v29
  v_mul_f32 v78, s33, v30
  v_mul_f32 v79, s33, v31
  v_mul_f32 v80, s33, v32
  v_mul_f32 v81, s33, v33
  v_mul_f32 v82, s33, v34
  v_mul_f32 v83, s33, v35
  v_mul_f32 v84, s33, v36
  v_mul_f32 v85, s33, v37
  v_mul_f32 v86, s33, v38
  v_mul_f32 v87, s33, v39
  v_mul_f32 v88, s33, v40
  v_mul_f32 v89, s33, v41
  v_mul_f32 v90, s33, v42
  v_mul_f32 v91, s33, v43
  v_mul_f32 v92, s33, v44
  v_mul_f32 v93, s33, v45
  v_mul_f32 v94, s33, v46
  v_mul_f32 v95, s33, v47
  v_exp_f32 v64, v64
  v_exp_f32 v65, v65
  v_exp_f32 v66, v66
  v_exp_f32 v67, v67
  v_exp_f32 v68, v68
  v_exp_f32 v69, v69
  v_exp_f32 v70, v70
  v_exp_f32 v71, v71
  v_exp_f32 v72, v72
  v_exp_f32 v73, v73
  v_exp_f32 v74, v74
  v_exp_f32 v75, v75
  v_exp_f32 v76, v76
  v_exp_f32 v77, v77
  v_exp_f32 v78, v78
  v_exp_f32 v79, v79
  v_exp_f32 v80, v80
  v_exp_f32 v81, v81
  v_exp_f32 v82, v82
  v_exp_f32 v83, v83
  v_exp_f32 v84, v84
  v_exp_f32 v85, v85
  v_exp_f32 v86, v86
  v_exp_f32 v87, v87
  v_exp_f32 v88, v88
  v_exp_f32 v89, v89
  v_exp_f32 v90, v90
  v_exp_f32 v91, v91
  v_exp_f32 v92, v92
  v_exp_f32 v93, v93
  v_exp_f32 v94, v94
  v_exp_f32 v95, v95
  s_nop 0
  v_pk_add_f32 v[64:65], v[64:65], 1.0 op_sel_hi:[1,0]
  v_pk_add_f32 v[66:67], v[66:67], 1.0 op_sel_hi:[1,0]
  v_pk_add_f32 v[68:69], v[68:69], 1.0 op_sel_hi:[1,0]
  v_pk_add_f32 v[70:71], v[70:71], 1.0 op_sel_hi:[1,0]
  v_pk_add_f32 v[72:73], v[72:73], 1.0 op_sel_hi:[1,0]
  v_pk_add_f32 v[74:75], v[74:75], 1.0 op_sel_hi:[1,0]
  v_pk_add_f32 v[76:77], v[76:77], 1.0 op_sel_hi:[1,0]
  v_pk_add_f32 v[78:79], v[78:79], 1.0 op_sel_hi:[1,0]
  v_pk_add_f32 v[80:81], v[80:81], 1.0 op_sel_hi:[1,0]
  v_pk_add_f32 v[82:83], v[82:83], 1.0 op_sel_hi:[1,0]
  v_pk_add_f32 v[84:85], v[84:85], 1.0 op_sel_hi:[1,0]
  v_pk_add_f32 v[86:87], v[86:87], 1.0 op_sel_hi:[1,0]
  v_pk_add_f32 v[88:89], v[88:89], 1.0 op_sel_hi:[1,0]
  v_pk_add_f32 v[90:91], v[90:91], 1.0 op_sel_hi:[1,0]
  v_pk_add_f32 v[92:93], v[92:93], 1.0 op_sel_hi:[1,0]
  v_pk_add_f32 v[94:95], v[94:95], 1.0 op_sel_hi:[1,0]
  v_rcp_f32 v64, v64
  v_rcp_f32 v65, v65
  v_rcp_f32 v66, v66
  v_rcp_f32 v67, v67
  v_rcp_f32 v68, v68
  v_rcp_f32 v69, v69
  v_rcp_f32 v70, v70
  v_rcp_f32 v71, v71
  v_rcp_f32 v72, v72
  v_rcp_f32 v73, v73
  v_rcp_f32 v74, v74
  v_rcp_f32 v75, v75
  v_rcp_f32 v76, v76
  v_rcp_f32 v77, v77
  v_rcp_f32 v78, v78
  v_rcp_f32 v79, v79
  v_rcp_f32 v80, v80
  v_rcp_f32 v81, v81
  v_rcp_f32 v82, v82
  v_rcp_f32 v83, v83
  v_rcp_f32 v84, v84
  v_rcp_f32 v85, v85
  v_rcp_f32 v86, v86
  v_rcp_f32 v87, v87
  v_rcp_f32 v88, v88
  v_rcp_f32 v89, v89
  v_rcp_f32 v90, v90
  v_rcp_f32 v91, v91
  v_rcp_f32 v92, v92
  v_rcp_f32 v93, v93
  v_rcp_f32 v94, v94
  v_rcp_f32 v95, v95
  s_nop 0
  v_pk_mul_f32 v[16:17], v[16:17], v[64:65]
  v_pk_mul_f32 v[18:19], v[18:19], v[66:67]
  v_pk_mul_f32 v[20:21], v[20:21], v[68:69]
  v_pk_mul_f32 v[22:23], v[22:23], v[70:71]
  v_pk_mul_f32 v[24:25], v[24:25], v[72:73]
  v_pk_mul_f32 v[26:27], v[26:27], v[74:75]
  v_pk_mul_f32 v[28:29], v[28:29], v[76:77]
  v_pk_mul_f32 v[30:31], v[30:31], v[78:79]
  v_pk_mul_f32 v[32:33], v[32:33], v[80:81]
  v_pk_mul_f32 v[34:35], v[34:35], v[82:83]
  v_pk_mul_f32 v[36:37], v[36:37], v[84:85]
  v_pk_mul_f32 v[38:39], v[38:39], v[86:87]
  v_pk_mul_f32 v[40:41], v[40:41], v[88:89]
  v_pk_mul_f32 v[42:43], v[42:43], v[90:91]
  v_pk_mul_f32 v[44:45], v[44:45], v[92:93]
  v_pk_mul_f32 v[46:47], v[46:47], v[94:95]
  s_xor_b32 s27, s24, 3
  s_lshl_b32 s27, s27, 14
  v_and_b32 v12, 15, v0
  v_lshrrev_b32 v13, 4, v0
  v_xor_b32 v13, v13, v12
  v_lshlrev_b32 v13, 4, v13
  v_lshl_add_u32 v12, v12, 8, v13
  v_add_u32 v8, s27, v12
  v_xor_b32 v9, 64, v8
  v_xor_b32 v10, 128, v8
  v_xor_b32 v11, 192, v8
  ds_write_b128 v8, v[16:19] offset:0
  ds_write_b128 v9, v[20:23] offset:0
  ds_write_b128 v10, v[24:27] offset:0
  ds_write_b128 v11, v[28:31] offset:0
  ds_write_b128 v8, v[32:35] offset:4096
  ds_write_b128 v9, v[36:39] offset:4096
  ds_write_b128 v10, v[40:43] offset:4096
  ds_write_b128 v11, v[44:47] offset:4096
  s_waitcnt lgkmcnt(0)
  s_endpgm
mega_end:
  s_endpgm
.section .rodata,"a"
.p2align 6
.amdhsa_kernel mega_kernel
  .amdhsa_next_free_vgpr 256
  .amdhsa_next_free_sgpr 102
  .amdhsa_accum_offset 256
  .amdhsa_group_segment_fixed_size 0
  .amdhsa_kernarg_size 80
  .amdhsa_user_sgpr_count 2
  .amdhsa_user_sgpr_kernarg_segment_ptr 1
  .amdhsa_system_sgpr_workgroup_id_x 1
  .amdhsa_float_denorm_mode_32 3
  .amdhsa_float_denorm_mode_16_64 3
.end_amdhsa_kernel
```
